```python
import torch

def _softmax(x, axis=-1):
    return torch.softmax(x, dim=axis)
def _gelu(x):
    return torch.nn.functional.gelu(x, approximate="tanh")
def _silu(x):
    return torch.nn.functional.silu(x)
def _sigmoid(x):
    return torch.sigmoid(x)
def _layernorm(x, axis=-1, eps=1e-5):
    m = x.mean(dim=axis, keepdim=True)
    v = x.var(dim=axis, keepdim=True, unbiased=False)
    return (x - m) / torch.sqrt(v + eps)
def _scatter_add(tgt, idx, src, axis=0):
    return tgt.clone().index_add_(axis, idx, src)
def _segment_sum(src, seg, n):
    out = torch.zeros((n,) + src.shape[1:], dtype=src.dtype)
    return out.index_add_(0, seg, src)
def _pad(x, pw):
    flat = tuple(v for pair in reversed(pw) for v in pair)
    return torch.nn.functional.pad(x, flat)

kernel_name = 'concat_heads__softmax_full_mha__linear_kernel_hedgehog__prompt'

def setup_inputs():

    _w = (lambda a: (lambda t: t.to(torch.bfloat16) if t.is_floating_point() else t)(torch.as_tensor(a)))
    def _A_setup():
        B, S, D = 1, 2048, 640
        return {
            "x": _w((lambda *s: torch.randn(*s, dtype=torch.bfloat16) * 0.2)(B, S, D)),
            "wqkv": _w((lambda *s: torch.randn(*s, dtype=torch.bfloat16) * 0.2)(D, 3 * D)),
            "wo": _w((lambda *s: torch.randn(*s, dtype=torch.bfloat16) * 0.05)(D, D)),
        }
    _A_in = _A_setup()

    def _B_setup():
        B, S, D, H = 1, 2048, 640, 32
        Dh = D // H
        return {
            "x": _w((lambda *s: torch.randn(*s, dtype=torch.bfloat16) * 0.4)(B, S, D)),
            "wqkv": _w((lambda *s: torch.randn(*s, dtype=torch.bfloat16) * 0.4)(D, 3 * D)),
            "w_phi": _w((lambda *s: torch.randn(*s, dtype=torch.bfloat16) * 0.4)(H, Dh, Dh) * (Dh ** -0.5)),
            "wo": _w((lambda *s: torch.randn(*s, dtype=torch.bfloat16) * 0.05)(D, D)),
        }
    _B_in = _B_setup()

    return {
        "A_x": _A_in["x"],
        "A_wqkv": _A_in["wqkv"],
        "A_wo": _A_in["wo"],
        "B_x": _B_in["x"],
        "B_wqkv": _B_in["wqkv"],
        "B_w_phi": _B_in["w_phi"],
        "B_wo": _B_in["wo"],
    }

def reference(A_x, A_wqkv, A_wo, B_x, B_wqkv, B_w_phi, B_wo):
    def _A_ref(x, wqkv, wo):
        B, S, D = x.shape
        H = 32; Dh = D // H
        qkv = (lambda x, *d: x.permute(*d))((x @ wqkv).reshape(B, S, 3, H, Dh), 2, 0, 3, 1, 4)
        q, k, v = qkv[0], qkv[1], qkv[2]
        scale = Dh ** -0.5
        scores = torch.einsum("bhqd,bhkd->bhqk", q, k) * scale
        p = _softmax(scores, axis=-1)
        o = torch.einsum("bhqk,bhkd->bhqd", p, v)
        return (lambda x, *d: x.permute(*d))(o, 0, 2, 1, 3).reshape(B, S, D) @ wo

    def _B_ref(x, wqkv, w_phi, wo):
        B, S, D = x.shape
        H = 32; Dh = D // H
        qkv = (lambda x, *d: x.permute(*d))((x @ wqkv).reshape(B, S, 3, H, Dh), 2, 0, 3, 1, 4)
        q, k, v = qkv[0], qkv[1], qkv[2]
        pq = torch.einsum("bhsd,hdf->bhsf", q, w_phi)
        pk = torch.einsum("bhsd,hdf->bhsf", k, w_phi)
        phi_q = torch.concatenate([_softmax(pq, axis=-1), _softmax(-pq, axis=-1)], axis=-1)
        phi_k = torch.concatenate([_softmax(pk, axis=-1), _softmax(-pk, axis=-1)], axis=-1)
        kv = torch.einsum("bhsf,bhsd->bhfd", phi_k, v)
        z  = torch.einsum("bhsf->bhf", phi_k)
        num = torch.einsum("bhqf,bhfd->bhqd", phi_q, kv)
        den = torch.einsum("bhqf,bhf->bhq", phi_q, z)[..., None] + 1e-6
        o = num / den
        return (lambda x, *d: x.permute(*d))(o, 0, 2, 1, 3).reshape(B, S, D) @ wo

    a = _A_ref(A_x, A_wqkv, A_wo)
    b = _B_ref(B_x, B_wqkv, B_w_phi, B_wo)
    return torch.concatenate([a, b], axis=-1)
```

```asm
; @launch grid=(256,1,1) block=(512,1,1) lds=163840
.amdgcn_target "amdgcn-amd-amdhsa--gfx950"
.text
.globl concat_heads__softmax_full_mha__linear_kernel_hedgehog__prompt_kernel
.p2align 8
.type concat_heads__softmax_full_mha__linear_kernel_hedgehog__prompt_kernel,@function
concat_heads__softmax_full_mha__linear_kernel_hedgehog__prompt_kernel:
    s_cmp_ge_u32 s2, 256
    s_cbranch_scc1 L_end
    s_load_dwordx16 s[64:79], s[0:1], 0
    s_load_dwordx4 s[80:83], s[0:1], 64
    v_lshrrev_b32 v1, 6, v0
    v_and_b32 v0, 63, v0
    s_and_b32 s25, s2, 7
    v_readfirstlane_b32 s3, v1
    s_lshr_b32 s26, s2, 3
    s_lshr_b32 s20, s25, 2
    s_and_b32 s21, s25, 1
    s_lshl_b32 s21, s21, 3
    s_and_b32 s27, s26, 7
    s_add_u32 s21, s21, s27
    s_lshr_b32 s22, s25, 1
    s_and_b32 s22, s22, 1
    s_lshl_b32 s22, s22, 2
    s_lshr_b32 s27, s26, 3
    s_add_u32 s22, s22, s27
    s_lshl_b32 s23, s21, 7
    s_mul_i32 s24, s22, 480
    s_cmp_ge_u32 s3, 4
    s_cbranch_scc0 L1_compute
    s_sub_u32 s30, s3, 4
    s_lshr_b32 s26, s2, 3
    s_lshr_b32 s57, s26, 3
    s_and_b32 s58, s26, 7
    v_lshrrev_b32 v1, 3, v0
    v_and_b32 v2, 7, v0
    v_lshrrev_b32 v3, 4, v0
    v_xor_b32 v3, v2, v3
    s_and_b32 s25, s30, 1
    s_lshl_b32 s25, s25, 2
    v_xor_b32 v3, s25, v3
    s_lshl_b32 s25, s30, 3
    s_add_u32 s25, s25, s23
    v_add_u32 v8, s25, v1
    v_mul_u32_u24 v8, 1280, v8
    v_lshl_add_u32 v10, v3, 4, v8
    v_lshrrev_b32 v1, 5, v0
    s_lshl_b32 s25, s30, 1
    v_add_u32 v8, s25, v1
    v_mul_u32_u24 v8, 3840, v8
    v_add_u32 v8, s24, v8
    v_bfe_u32 v9, v0, 3, 2
    v_mul_u32_u24 v3, 120, v9
    v_add_u32 v8, v8, v3
    v_lshrrev_b32 v9, 1, v9
    v_lshlrev_b32 v9, 3, v9
    v_sub_u32 v8, v8, v9
    v_xor_b32 v3, v2, v1
    s_and_b32 s25, s30, 1
    s_lshl_b32 s25, s25, 1
    v_xor_b32 v3, s25, v3
    s_and_b32 s25, s58, 1
    s_lshl_b32 s25, s25, 2
    v_xor_b32 v3, s25, v3
    v_lshl_add_u32 v24, v3, 4, v8
    v_xor_b32 v3, 4, v3
    v_lshl_add_u32 v25, v3, 4, v8
    s_lshl_b32 s26, s30, 10
    s_add_u32 s27, s26, 49152
    s_waitcnt lgkmcnt(0)
    s_cmp_eq_u32 s20, 0
    s_cselect_b32 s4, s64, s70
    s_cselect_b32 s5, s65, s71
    s_cselect_b32 s6, s66, s72
    s_cselect_b32 s7, s67, s73
    s_mov_b32 s8, s4
    s_mov_b32 s9, s5
    s_mov_b32 s10, 2621440
    s_mov_b32 s11, 0x00020000
    s_mov_b32 s12, s6
    s_mov_b32 s13, s7
    s_mov_b32 s14, 2457600
    s_mov_b32 s15, 0x00020000
    s_mov_b32 s36, s27
    s_mov_b32 s37, s26
    s_mov_b32 s38, 0
    s_mov_b32 s39, 0
    s_mov_b32 s43, 0
    s_mov_b32 s44, 0
L1_stage:
    s_mov_b32 s40, s58
    s_mov_b32 s41, s57
    s_mov_b32 s42, 4
L1_issue:
    s_lshl_b32 s29, s40, 12
    s_add_u32 m0, s29, s36
    s_mul_i32 s28, s40, 30720
    s_add_u32 s28, s28, s38
    buffer_load_dwordx4 v24, s[12:15], s28 offen  lds
    s_add_u32 s40, s40, 1
    s_and_b32 s40, s40, 7
    s_lshl_b32 s29, s41, 12
    s_add_u32 m0, s29, s37
    s_mul_i32 s28, s41, 40960
    s_add_u32 s28, s28, s39
    buffer_load_dwordx4 v10, s[8:11], s28 offen  lds
    s_add_u32 s41, s41, 1
    s_and_b32 s41, s41, 3
    s_lshl_b32 s29, s40, 12
    s_add_u32 m0, s29, s36
    s_mul_i32 s28, s40, 30720
    s_add_u32 s28, s28, s38
    buffer_load_dwordx4 v25, s[12:15], s28 offen  lds
    s_add_u32 s40, s40, 1
    s_and_b32 s40, s40, 7
    s_sub_u32 s42, s42, 1
    s_cmp_lg_u32 s42, 0
    s_cbranch_scc1 L1_issue
    s_add_u32 s38, s38, 245760
    s_add_u32 s39, s39, 128
    s_add_u32 s43, s43, 1
    s_cmp_eq_u32 s43, 3
    s_cselect_b32 s43, 0, s43
    s_lshl_b32 s25, s43, 15
    s_add_u32 s36, s27, s25
    s_lshl_b32 s25, s43, 14
    s_add_u32 s37, s26, s25
    s_add_u32 s44, s44, 1
    s_cmp_eq_u32 s44, 1
    s_cbranch_scc1 L1_stage
    s_cmp_eq_u32 s44, 3
    s_cbranch_scc1 L1_misc
L1_miscret:
    s_waitcnt vmcnt(12)
    s_barrier
    s_cmp_lt_u32 s44, 10
    s_cbranch_scc1 L1_stage
    s_waitcnt vmcnt(0)
    s_barrier
    s_branch L1_ldone
L1_misc:
    s_cmp_lg_u32 s30, 0
    s_cbranch_scc1 L1_miscret
    s_lshl_b32 s62, s20, 7
    s_lshl_b32 s59, s22, 4
    s_add_u32 s62, s62, s59
    s_add_u32 s62, s62, s21
    s_and_b32 s59, s2, 7
    s_lshl_b32 s85, s59, 2
    s_lshr_b32 s59, s2, 6
    s_add_u32 s85, s85, s59
    s_lshr_b32 s59, s2, 3
    s_and_b32 s86, s59, 7
    s_mov_b32 s32, s80
    s_mov_b32 s33, s81
    s_mov_b32 s34, 256
    s_mov_b32 s35, 0x00020000
    v_mov_b32 v9, 0
    s_mov_b32 s52, s74
    s_mov_b32 s53, s75
    s_mov_b32 s54, 25600
    s_mov_b32 s55, 0x00020000
    s_mul_i32 s56, s85, 800
    s_mov_b32 m0, 147456
    v_lshlrev_b32 v1, 4, v0
    s_mov_b32 exec_hi, 0x3ffff
    buffer_load_dwordx4 v1, s[52:55], s56 offen lds
    s_mov_b64 exec, -1
    s_cmp_lg_u32 s2, 0
    s_cbranch_scc1 L1_miscret
    s_add_u32 s96, s82, 33554432
    s_addc_u32 s97, s83, 0
    s_mov_b32 s98, 262144
    s_mov_b32 s99, 0x00020000
    v_mov_b32 v7, 262016
    s_mov_b64 exec, 1
    buffer_load_dword v8, v7, s[96:99], 0 offen sc1
    s_mov_b32 s48, 0x2c9277b5
    s_waitcnt vmcnt(0)
    v_mul_lo_u32 v8, v8, s48
    v_add_u32 v8, 0x9e3779b9, v8
    v_max_u32 v8, 1, v8
    buffer_store_dword v8, v7, s[96:99], 0 offen sc1
    buffer_store_dword v8, v9, s[32:35], 0 offen sc1
    s_mov_b64 exec, -1
    s_branch L1_miscret
L1_ldone:
    s_lshl_b32 s62, s20, 7
    s_lshl_b32 s59, s22, 4
    s_add_u32 s62, s62, s59
    s_add_u32 s62, s62, s21
    s_and_b32 s59, s2, 7
    s_lshl_b32 s85, s59, 2
    s_lshr_b32 s59, s2, 6
    s_add_u32 s85, s85, s59
    s_lshr_b32 s59, s2, 3
    s_and_b32 s86, s59, 7
    s_mov_b32 s16, s82
    s_mov_b32 s17, s83
    s_mov_b32 s18, 18874368
    s_mov_b32 s19, 0x00020000
    s_add_u32 s96, s82, 33554432
    s_addc_u32 s97, s83, 0
    s_mov_b32 s98, 262144
    s_mov_b32 s99, 0x00020000
    s_mov_b32 s32, s80
    s_mov_b32 s33, s81
    s_mov_b32 s34, 256
    s_mov_b32 s35, 0x00020000
    v_mov_b32 v9, 0
    buffer_load_dword v18, v9, s[32:35], 0 offen sc1
    s_waitcnt vmcnt(0)
    v_readfirstlane_b32 s84, v18
    s_cmp_lg_u32 s84, 0
    s_cbranch_scc1 L1_havenonce
    s_mov_b32 s36, 0
L1_noncepoll:
    buffer_load_dword v18, v9, s[32:35], 0 offen sc1
    s_waitcnt vmcnt(0)
    v_readfirstlane_b32 s84, v18
    s_add_u32 s36, s36, 1
    s_cmp_lg_u32 s84, 0
    s_cbranch_scc1 L1_havenonce
    s_cmp_lt_u32 s36, 0x100000
    s_cbranch_scc0 L1_havenonce
    s_branch L1_noncepoll
L1_havenonce:
    s_branch L1_join
L1_compute:
    s_lshr_b32 s26, s2, 3
    s_getpc_b64 s[40:41]
L_pc:
    s_mul_i32 s42, s26, 12
    v_add_u32 v2, s42, v0
    v_lshlrev_b32 v3, 7, v2
    v_cmp_gt_u32 vcc, 12, v0
    s_mov_b32 s43, L_end-L_pc
    v_cmp_gt_u32 s[44:45], s43, v3
    s_nop 1
    s_and_b64 vcc, vcc, s[44:45]
    s_cmp_eq_u32 s3, 3
    s_cselect_b64 vcc, vcc, 0
    s_and_saveexec_b64 s[44:45], vcc
    s_cbranch_execz L_nocode
    global_load_dword v254, v3, s[40:41]
L_nocode:
    s_mov_b64 exec, s[44:45]
    s_waitcnt lgkmcnt(0)
    s_lshl_b32 s62, s20, 7
    s_lshl_b32 s59, s22, 4
    s_add_u32 s62, s62, s59
    s_add_u32 s62, s62, s21
    s_and_b32 s59, s2, 7
    s_lshl_b32 s85, s59, 2
    s_lshr_b32 s59, s2, 6
    s_add_u32 s85, s85, s59
    s_lshr_b32 s59, s2, 3
    s_and_b32 s86, s59, 7
    s_mov_b32 s16, s82
    s_mov_b32 s17, s83
    s_mov_b32 s18, 18874368
    s_mov_b32 s19, 0x00020000
    s_add_u32 s96, s82, 33554432
    s_addc_u32 s97, s83, 0
    s_mov_b32 s98, 262144
    s_mov_b32 s99, 0x00020000
    v_and_b32 v1, 15, v0
    v_lshrrev_b32 v2, 4, v0
    v_bfe_u32 v3, v0, 1, 3
    v_xor_b32 v3, v3, v2
    s_lshl_b32 s27, s3, 12
    v_lshlrev_b32 v6, 7, v1
    v_lshl_add_u32 v6, v3, 4, v6
    v_add_u32 v6, s27, v6
    v_mov_b32 v4, v6
    v_xor_b32 v5, 64, v6
    v_bfe_u32 v3, v0, 2, 2
    v_lshl_add_u32 v6, v2, 3, v3
    v_lshlrev_b32 v6, 9, v6
    v_and_b32 v7, 3, v0
    v_lshl_add_u32 v6, v7, 7, v6
    v_add_u32 v6, 49152, v6
    v_and_b32 v30, 1, v2
    v_lshl_or_b32 v3, v30, 2, v3
    v_lshrrev_b32 v7, 1, v7
    v_lshlrev_b32 v7, 3, v7
    v_lshl_or_b32 v6, v3, 4, v6
    v_add_u32 v30, 0, v7
    v_xor_b32 v160, v6, v30
    v_add_u32 v175, 0x10000, v160
    v_add_u32 v30, 8, v7
    v_xor_b32 v161, v6, v30
    v_add_u32 v176, 0x10000, v161
    v_add_u32 v30, 16, v7
    v_xor_b32 v162, v6, v30
    v_add_u32 v177, 0x10000, v162
    v_add_u32 v30, 24, v7
    v_xor_b32 v163, v6, v30
    v_add_u32 v178, 0x10000, v163
    v_add_u32 v30, 32, v7
    v_xor_b32 v164, v6, v30
    v_add_u32 v179, 0x10000, v164
    v_add_u32 v30, 40, v7
    v_xor_b32 v165, v6, v30
    v_add_u32 v180, 0x10000, v165
    v_add_u32 v30, 48, v7
    v_xor_b32 v166, v6, v30
    v_add_u32 v181, 0x10000, v166
    v_add_u32 v30, 56, v7
    v_xor_b32 v167, v6, v30
    v_add_u32 v182, 0x10000, v167
    v_add_u32 v30, 64, v7
    v_xor_b32 v168, v6, v30
    v_add_u32 v183, 0x10000, v168
    v_add_u32 v30, 72, v7
    v_xor_b32 v169, v6, v30
    v_add_u32 v184, 0x10000, v169
    v_add_u32 v30, 80, v7
    v_xor_b32 v170, v6, v30
    v_add_u32 v185, 0x10000, v170
    v_add_u32 v30, 88, v7
    v_xor_b32 v171, v6, v30
    v_add_u32 v186, 0x10000, v171
    v_add_u32 v30, 96, v7
    v_xor_b32 v172, v6, v30
    v_add_u32 v187, 0x10000, v172
    v_add_u32 v30, 104, v7
    v_xor_b32 v173, v6, v30
    v_add_u32 v188, 0x10000, v173
    v_add_u32 v30, 112, v7
    v_xor_b32 v174, v6, v30
    v_add_u32 v189, 0x10000, v174
    s_mul_i32 s27, s20, 96
    s_mul_i32 s29, s22, 12
    s_add_u32 s28, s27, s29
    v_mul_u32_u24 v35, 3, v2
    v_add_u32 v36, s28, v35
    s_mov_b32 s30, 98304
    v_mul_lo_u32 v36, v36, s30
    s_lshl_b32 s31, s3, 5
    s_add_u32 s31, s31, s23
    v_add_u32 v37, s31, v1
    v_lshl_add_u32 v34, v37, 4, v36
    v_add_u32 v35, s29, v35
    v_mov_b32 v36, 0x3f80
    v_mov_b32 v38, 0x3ea52b5c
    v_add_u32 v37, 0, v35
    v_cmp_le_u32 vcc, 64, v37
    v_cmp_gt_u32 s[36:37], 32, v37
    s_nop 1
    v_cndmask_b32 v24, 0, v36, vcc
    v_cndmask_b32 v28, 1.0, v38, s[36:37]
    v_add_u32 v37, 1, v35
    v_cmp_le_u32 vcc, 64, v37
    v_cmp_gt_u32 s[36:37], 32, v37
    s_nop 1
    v_cndmask_b32 v25, 0, v36, vcc
    v_cndmask_b32 v30, 1.0, v38, s[36:37]
    v_add_u32 v37, 2, v35
    v_cmp_le_u32 vcc, 64, v37
    v_cmp_gt_u32 s[36:37], 32, v37
    s_nop 1
    v_cndmask_b32 v26, 0, v36, vcc
    v_cndmask_b32 v32, 1.0, v38, s[36:37]
    s_cmp_lt_u32 s22, 3
    s_cselect_b32 s33, 1, 0
    s_cmp_eq_u32 s20, 0
    s_cselect_b32 s33, s33, 0
    s_barrier
    ds_read_b128 v[8:11], v4 offset:0
    ds_read_b128 v[12:15], v4 offset:2048
    ds_read_b64_tr_b16 v[192:193], v160 offset:0
    ds_read_b64_tr_b16 v[194:195], v160 offset:2048
    ds_read_b64_tr_b16 v[196:197], v161 offset:0
    ds_read_b64_tr_b16 v[198:199], v161 offset:2048
    ds_read_b64_tr_b16 v[200:201], v162 offset:0
    ds_read_b64_tr_b16 v[202:203], v162 offset:2048
    ds_read_b64_tr_b16 v[204:205], v163 offset:0
    ds_read_b64_tr_b16 v[206:207], v163 offset:2048
    ds_read_b64_tr_b16 v[208:209], v164 offset:0
    ds_read_b64_tr_b16 v[210:211], v164 offset:2048
    s_waitcnt lgkmcnt(8)
    v_mfma_f32_16x16x32_bf16 v[40:43], v[192:195], v[8:11], 0
    ds_read_b64_tr_b16 v[212:213], v165 offset:0
    ds_read_b64_tr_b16 v[214:215], v165 offset:2048
    v_mfma_f32_16x16x32_bf16 v[100:103], v[192:195], v[12:15], 0
    s_waitcnt lgkmcnt(8)
    v_mfma_f32_16x16x32_bf16 v[44:47], v[196:199], v[8:11], 0
    ds_read_b64_tr_b16 v[216:217], v166 offset:0
    ds_read_b64_tr_b16 v[218:219], v166 offset:2048
    v_mfma_f32_16x16x32_bf16 v[104:107], v[196:199], v[12:15], 0
    s_waitcnt lgkmcnt(8)
    v_mfma_f32_16x16x32_bf16 v[48:51], v[200:203], v[8:11], 0
    ds_read_b64_tr_b16 v[220:221], v167 offset:0
    ds_read_b64_tr_b16 v[222:223], v167 offset:2048
    v_mfma_f32_16x16x32_bf16 v[108:111], v[200:203], v[12:15], 0
    ds_read_b128 v[16:19], v5 offset:0
    ds_read_b128 v[20:23], v5 offset:2048
    s_waitcnt lgkmcnt(10)
    v_mfma_f32_16x16x32_bf16 v[52:55], v[204:207], v[8:11], 0
    ds_read_b64_tr_b16 v[192:193], v168 offset:0
    ds_read_b64_tr_b16 v[194:195], v168 offset:2048
    v_mfma_f32_16x16x32_bf16 v[112:115], v[204:207], v[12:15], 0
    s_waitcnt lgkmcnt(10)
    v_mfma_f32_16x16x32_bf16 v[56:59], v[208:211], v[8:11], 0
    ds_read_b64_tr_b16 v[196:197], v169 offset:0
    ds_read_b64_tr_b16 v[198:199], v169 offset:2048
    v_mfma_f32_16x16x32_bf16 v[116:119], v[208:211], v[12:15], 0
    s_waitcnt lgkmcnt(10)
    v_mfma_f32_16x16x32_bf16 v[60:63], v[212:215], v[8:11], 0
    ds_read_b64_tr_b16 v[200:201], v170 offset:0
    ds_read_b64_tr_b16 v[202:203], v170 offset:2048
    v_mfma_f32_16x16x32_bf16 v[120:123], v[212:215], v[12:15], 0
    s_waitcnt lgkmcnt(10)
    v_mfma_f32_16x16x32_bf16 v[64:67], v[216:219], v[8:11], 0
    ds_read_b64_tr_b16 v[204:205], v171 offset:0
    ds_read_b64_tr_b16 v[206:207], v171 offset:2048
    v_mfma_f32_16x16x32_bf16 v[124:127], v[216:219], v[12:15], 0
    s_waitcnt lgkmcnt(10)
    v_mfma_f32_16x16x32_bf16 v[68:71], v[220:223], v[8:11], 0
    ds_read_b64_tr_b16 v[208:209], v172 offset:0
    ds_read_b64_tr_b16 v[210:211], v172 offset:2048
    v_mfma_f32_16x16x32_bf16 v[128:131], v[220:223], v[12:15], 0
    s_waitcnt lgkmcnt(8)
    v_mfma_f32_16x16x32_bf16 v[72:75], v[192:195], v[8:11], 0
    ds_read_b64_tr_b16 v[212:213], v173 offset:0
    ds_read_b64_tr_b16 v[214:215], v173 offset:2048
    v_mfma_f32_16x16x32_bf16 v[132:135], v[192:195], v[12:15], 0
    s_waitcnt lgkmcnt(8)
    v_mfma_f32_16x16x32_bf16 v[76:79], v[196:199], v[8:11], 0
    ds_read_b64_tr_b16 v[216:217], v174 offset:0
    ds_read_b64_tr_b16 v[218:219], v174 offset:2048
    v_mfma_f32_16x16x32_bf16 v[136:139], v[196:199], v[12:15], 0
    s_waitcnt lgkmcnt(8)
    v_mfma_f32_16x16x32_bf16 v[80:83], v[200:203], v[8:11], 0
    ds_read_b64_tr_b16 v[220:221], v160 offset:16384
    ds_read_b64_tr_b16 v[222:223], v160 offset:18432
    v_mfma_f32_16x16x32_bf16 v[140:143], v[200:203], v[12:15], 0
    s_waitcnt lgkmcnt(8)
    v_mfma_f32_16x16x32_bf16 v[84:87], v[204:207], v[8:11], 0
    ds_read_b64_tr_b16 v[192:193], v161 offset:16384
    ds_read_b64_tr_b16 v[194:195], v161 offset:18432
    v_mfma_f32_16x16x32_bf16 v[144:147], v[204:207], v[12:15], 0
    s_waitcnt lgkmcnt(8)
    v_mfma_f32_16x16x32_bf16 v[88:91], v[208:211], v[8:11], 0
    ds_read_b64_tr_b16 v[196:197], v162 offset:16384
    ds_read_b64_tr_b16 v[198:199], v162 offset:18432
    v_mfma_f32_16x16x32_bf16 v[148:151], v[208:211], v[12:15], 0
    s_waitcnt lgkmcnt(8)
    v_mfma_f32_16x16x32_bf16 v[92:95], v[212:215], v[8:11], 0
    ds_read_b64_tr_b16 v[200:201], v163 offset:16384
    ds_read_b64_tr_b16 v[202:203], v163 offset:18432
    v_mfma_f32_16x16x32_bf16 v[152:155], v[212:215], v[12:15], 0
    s_waitcnt lgkmcnt(8)
    v_mfma_f32_16x16x32_bf16 v[96:99], v[216:219], v[8:11], 0
    ds_read_b64_tr_b16 v[204:205], v164 offset:16384
    ds_read_b64_tr_b16 v[206:207], v164 offset:18432
    v_mfma_f32_16x16x32_bf16 v[156:159], v[216:219], v[12:15], 0
    s_waitcnt lgkmcnt(8)
    v_mfma_f32_16x16x32_bf16 v[40:43], v[220:223], v[16:19], v[40:43]
    ds_read_b64_tr_b16 v[208:209], v165 offset:16384
    ds_read_b64_tr_b16 v[210:211], v165 offset:18432
    v_mfma_f32_16x16x32_bf16 v[100:103], v[220:223], v[20:23], v[100:103]
    s_waitcnt lgkmcnt(8)
    v_mfma_f32_16x16x32_bf16 v[44:47], v[192:195], v[16:19], v[44:47]
    ds_read_b64_tr_b16 v[212:213], v166 offset:16384
    ds_read_b64_tr_b16 v[214:215], v166 offset:18432
    v_mfma_f32_16x16x32_bf16 v[104:107], v[192:195], v[20:23], v[104:107]
    s_waitcnt lgkmcnt(8)
    v_mfma_f32_16x16x32_bf16 v[48:51], v[196:199], v[16:19], v[48:51]
    ds_read_b64_tr_b16 v[216:217], v167 offset:16384
    ds_read_b64_tr_b16 v[218:219], v167 offset:18432
    v_mfma_f32_16x16x32_bf16 v[108:111], v[196:199], v[20:23], v[108:111]
    s_waitcnt lgkmcnt(8)
    v_mfma_f32_16x16x32_bf16 v[52:55], v[200:203], v[16:19], v[52:55]
    ds_read_b64_tr_b16 v[220:221], v168 offset:16384
    ds_read_b64_tr_b16 v[222:223], v168 offset:18432
    v_mfma_f32_16x16x32_bf16 v[112:115], v[200:203], v[20:23], v[112:115]
    s_waitcnt lgkmcnt(8)
    v_mfma_f32_16x16x32_bf16 v[56:59], v[204:207], v[16:19], v[56:59]
    ds_read_b64_tr_b16 v[192:193], v169 offset:16384
    ds_read_b64_tr_b16 v[194:195], v169 offset:18432
    v_mfma_f32_16x16x32_bf16 v[116:119], v[204:207], v[20:23], v[116:119]
    s_waitcnt lgkmcnt(8)
    v_mfma_f32_16x16x32_bf16 v[60:63], v[208:211], v[16:19], v[60:63]
    ds_read_b64_tr_b16 v[196:197], v170 offset:16384
    ds_read_b64_tr_b16 v[198:199], v170 offset:18432
    v_mfma_f32_16x16x32_bf16 v[120:123], v[208:211], v[20:23], v[120:123]
    s_waitcnt lgkmcnt(8)
    v_mfma_f32_16x16x32_bf16 v[64:67], v[212:215], v[16:19], v[64:67]
    ds_read_b64_tr_b16 v[200:201], v171 offset:16384
    ds_read_b64_tr_b16 v[202:203], v171 offset:18432
    v_mfma_f32_16x16x32_bf16 v[124:127], v[212:215], v[20:23], v[124:127]
    ds_read_b64_tr_b16 v[204:205], v172 offset:16384
    ds_read_b64_tr_b16 v[206:207], v172 offset:18432
    s_waitcnt lgkmcnt(10)
    v_mfma_f32_16x16x32_bf16 v[68:71], v[216:219], v[16:19], v[68:71]
    ds_read_b64_tr_b16 v[208:209], v173 offset:16384
    ds_read_b64_tr_b16 v[210:211], v173 offset:18432
    v_mfma_f32_16x16x32_bf16 v[128:131], v[216:219], v[20:23], v[128:131]
    ds_read_b64_tr_b16 v[212:213], v174 offset:16384
    ds_read_b64_tr_b16 v[214:215], v174 offset:18432
    s_waitcnt lgkmcnt(12)
    v_mfma_f32_16x16x32_bf16 v[72:75], v[220:223], v[16:19], v[72:75]
    v_mfma_f32_16x16x32_bf16 v[132:135], v[220:223], v[20:23], v[132:135]
    s_waitcnt lgkmcnt(10)
    v_mfma_f32_16x16x32_bf16 v[76:79], v[192:195], v[16:19], v[76:79]
    v_mfma_f32_16x16x32_bf16 v[136:139], v[192:195], v[20:23], v[136:139]
    s_waitcnt lgkmcnt(0)
    s_barrier
    v_mfma_f32_16x16x32_bf16 v[80:83], v[196:199], v[16:19], v[80:83]
    ds_read_b64_tr_b16 v[216:217], v160 offset:32768
    ds_read_b64_tr_b16 v[218:219], v160 offset:34816
    v_mfma_f32_16x16x32_bf16 v[140:143], v[196:199], v[20:23], v[140:143]
    v_mfma_f32_16x16x32_bf16 v[84:87], v[200:203], v[16:19], v[84:87]
    ds_read_b64_tr_b16 v[220:221], v161 offset:32768
    ds_read_b64_tr_b16 v[222:223], v161 offset:34816
    v_mfma_f32_16x16x32_bf16 v[144:147], v[200:203], v[20:23], v[144:147]
    ds_read_b128 v[8:11], v4 offset:16384
    ds_read_b128 v[12:15], v4 offset:18432
    v_mfma_f32_16x16x32_bf16 v[88:91], v[204:207], v[16:19], v[88:91]
    ds_read_b64_tr_b16 v[192:193], v162 offset:32768
    ds_read_b64_tr_b16 v[194:195], v162 offset:34816
    v_mfma_f32_16x16x32_bf16 v[148:151], v[204:207], v[20:23], v[148:151]
    v_mfma_f32_16x16x32_bf16 v[92:95], v[208:211], v[16:19], v[92:95]
    ds_read_b64_tr_b16 v[196:197], v163 offset:32768
    ds_read_b64_tr_b16 v[198:199], v163 offset:34816
    v_mfma_f32_16x16x32_bf16 v[152:155], v[208:211], v[20:23], v[152:155]
    v_mfma_f32_16x16x32_bf16 v[96:99], v[212:215], v[16:19], v[96:99]
    ds_read_b64_tr_b16 v[200:201], v164 offset:32768
    ds_read_b64_tr_b16 v[202:203], v164 offset:34816
    v_mfma_f32_16x16x32_bf16 v[156:159], v[212:215], v[20:23], v[156:159]
    s_waitcnt lgkmcnt(6)
    v_mfma_f32_16x16x32_bf16 v[40:43], v[216:219], v[8:11], v[40:43]
    ds_read_b64_tr_b16 v[204:205], v165 offset:32768
    ds_read_b64_tr_b16 v[206:207], v165 offset:34816
    v_mfma_f32_16x16x32_bf16 v[100:103], v[216:219], v[12:15], v[100:103]
    s_waitcnt lgkmcnt(8)
    v_mfma_f32_16x16x32_bf16 v[44:47], v[220:223], v[8:11], v[44:47]
    ds_read_b64_tr_b16 v[208:209], v166 offset:32768
    ds_read_b64_tr_b16 v[210:211], v166 offset:34816
    v_mfma_f32_16x16x32_bf16 v[104:107], v[220:223], v[12:15], v[104:107]
    s_waitcnt lgkmcnt(8)
    v_mfma_f32_16x16x32_bf16 v[48:51], v[192:195], v[8:11], v[48:51]
    ds_read_b64_tr_b16 v[212:213], v167 offset:32768
    ds_read_b64_tr_b16 v[214:215], v167 offset:34816
    v_mfma_f32_16x16x32_bf16 v[108:111], v[192:195], v[12:15], v[108:111]
    ds_read_b128 v[16:19], v5 offset:16384
    ds_read_b128 v[20:23], v5 offset:18432
    s_waitcnt lgkmcnt(10)
    v_mfma_f32_16x16x32_bf16 v[52:55], v[196:199], v[8:11], v[52:55]
    ds_read_b64_tr_b16 v[216:217], v168 offset:32768
    ds_read_b64_tr_b16 v[218:219], v168 offset:34816
    v_mfma_f32_16x16x32_bf16 v[112:115], v[196:199], v[12:15], v[112:115]
    s_waitcnt lgkmcnt(10)
    v_mfma_f32_16x16x32_bf16 v[56:59], v[200:203], v[8:11], v[56:59]
    ds_read_b64_tr_b16 v[220:221], v169 offset:32768
    ds_read_b64_tr_b16 v[222:223], v169 offset:34816
    v_mfma_f32_16x16x32_bf16 v[116:119], v[200:203], v[12:15], v[116:119]
    s_waitcnt lgkmcnt(10)
    v_mfma_f32_16x16x32_bf16 v[60:63], v[204:207], v[8:11], v[60:63]
    ds_read_b64_tr_b16 v[192:193], v170 offset:32768
    ds_read_b64_tr_b16 v[194:195], v170 offset:34816
    v_mfma_f32_16x16x32_bf16 v[120:123], v[204:207], v[12:15], v[120:123]
    s_waitcnt lgkmcnt(10)
    v_mfma_f32_16x16x32_bf16 v[64:67], v[208:211], v[8:11], v[64:67]
    ds_read_b64_tr_b16 v[196:197], v171 offset:32768
    ds_read_b64_tr_b16 v[198:199], v171 offset:34816
    v_mfma_f32_16x16x32_bf16 v[124:127], v[208:211], v[12:15], v[124:127]
    s_waitcnt lgkmcnt(10)
    v_mfma_f32_16x16x32_bf16 v[68:71], v[212:215], v[8:11], v[68:71]
    ds_read_b64_tr_b16 v[200:201], v172 offset:32768
    ds_read_b64_tr_b16 v[202:203], v172 offset:34816
    v_mfma_f32_16x16x32_bf16 v[128:131], v[212:215], v[12:15], v[128:131]
    s_waitcnt lgkmcnt(8)
    v_mfma_f32_16x16x32_bf16 v[72:75], v[216:219], v[8:11], v[72:75]
    ds_read_b64_tr_b16 v[204:205], v173 offset:32768
    ds_read_b64_tr_b16 v[206:207], v173 offset:34816
    v_mfma_f32_16x16x32_bf16 v[132:135], v[216:219], v[12:15], v[132:135]
    s_waitcnt lgkmcnt(8)
    v_mfma_f32_16x16x32_bf16 v[76:79], v[220:223], v[8:11], v[76:79]
    ds_read_b64_tr_b16 v[208:209], v174 offset:32768
    ds_read_b64_tr_b16 v[210:211], v174 offset:34816
    v_mfma_f32_16x16x32_bf16 v[136:139], v[220:223], v[12:15], v[136:139]
    s_waitcnt lgkmcnt(8)
    v_mfma_f32_16x16x32_bf16 v[80:83], v[192:195], v[8:11], v[80:83]
    ds_read_b64_tr_b16 v[212:213], v160 offset:49152
    ds_read_b64_tr_b16 v[214:215], v160 offset:51200
    v_mfma_f32_16x16x32_bf16 v[140:143], v[192:195], v[12:15], v[140:143]
    s_waitcnt lgkmcnt(8)
    v_mfma_f32_16x16x32_bf16 v[84:87], v[196:199], v[8:11], v[84:87]
    ds_read_b64_tr_b16 v[216:217], v161 offset:49152
    ds_read_b64_tr_b16 v[218:219], v161 offset:51200
    v_mfma_f32_16x16x32_bf16 v[144:147], v[196:199], v[12:15], v[144:147]
    s_waitcnt lgkmcnt(8)
    v_mfma_f32_16x16x32_bf16 v[88:91], v[200:203], v[8:11], v[88:91]
    ds_read_b64_tr_b16 v[220:221], v162 offset:49152
    ds_read_b64_tr_b16 v[222:223], v162 offset:51200
    v_mfma_f32_16x16x32_bf16 v[148:151], v[200:203], v[12:15], v[148:151]
    s_waitcnt lgkmcnt(8)
    v_mfma_f32_16x16x32_bf16 v[92:95], v[204:207], v[8:11], v[92:95]
    ds_read_b64_tr_b16 v[192:193], v163 offset:49152
    ds_read_b64_tr_b16 v[194:195], v163 offset:51200
    v_mfma_f32_16x16x32_bf16 v[152:155], v[204:207], v[12:15], v[152:155]
    s_waitcnt lgkmcnt(8)
    v_mfma_f32_16x16x32_bf16 v[96:99], v[208:211], v[8:11], v[96:99]
    ds_read_b64_tr_b16 v[196:197], v164 offset:49152
    ds_read_b64_tr_b16 v[198:199], v164 offset:51200
    v_mfma_f32_16x16x32_bf16 v[156:159], v[208:211], v[12:15], v[156:159]
    s_waitcnt lgkmcnt(8)
    v_mfma_f32_16x16x32_bf16 v[40:43], v[212:215], v[16:19], v[40:43]
    ds_read_b64_tr_b16 v[200:201], v165 offset:49152
    ds_read_b64_tr_b16 v[202:203], v165 offset:51200
    v_mfma_f32_16x16x32_bf16 v[100:103], v[212:215], v[20:23], v[100:103]
    s_waitcnt lgkmcnt(8)
    v_mfma_f32_16x16x32_bf16 v[44:47], v[216:219], v[16:19], v[44:47]
    ds_read_b64_tr_b16 v[204:205], v166 offset:49152
    ds_read_b64_tr_b16 v[206:207], v166 offset:51200
    v_mfma_f32_16x16x32_bf16 v[104:107], v[216:219], v[20:23], v[104:107]
    s_waitcnt lgkmcnt(8)
    v_mfma_f32_16x16x32_bf16 v[48:51], v[220:223], v[16:19], v[48:51]
    ds_read_b64_tr_b16 v[208:209], v167 offset:49152
    ds_read_b64_tr_b16 v[210:211], v167 offset:51200
    v_mfma_f32_16x16x32_bf16 v[108:111], v[220:223], v[20:23], v[108:111]
    s_waitcnt lgkmcnt(8)
    v_mfma_f32_16x16x32_bf16 v[52:55], v[192:195], v[16:19], v[52:55]
    ds_read_b64_tr_b16 v[212:213], v168 offset:49152
    ds_read_b64_tr_b16 v[214:215], v168 offset:51200
    v_mfma_f32_16x16x32_bf16 v[112:115], v[192:195], v[20:23], v[112:115]
    s_waitcnt lgkmcnt(8)
    v_mfma_f32_16x16x32_bf16 v[56:59], v[196:199], v[16:19], v[56:59]
    ds_read_b64_tr_b16 v[216:217], v169 offset:49152
    ds_read_b64_tr_b16 v[218:219], v169 offset:51200
    v_mfma_f32_16x16x32_bf16 v[116:119], v[196:199], v[20:23], v[116:119]
    s_waitcnt lgkmcnt(8)
    v_mfma_f32_16x16x32_bf16 v[60:63], v[200:203], v[16:19], v[60:63]
    ds_read_b64_tr_b16 v[220:221], v170 offset:49152
    ds_read_b64_tr_b16 v[222:223], v170 offset:51200
    v_mfma_f32_16x16x32_bf16 v[120:123], v[200:203], v[20:23], v[120:123]
    s_waitcnt lgkmcnt(8)
    v_mfma_f32_16x16x32_bf16 v[64:67], v[204:207], v[16:19], v[64:67]
    ds_read_b64_tr_b16 v[192:193], v171 offset:49152
    ds_read_b64_tr_b16 v[194:195], v171 offset:51200
    v_mfma_f32_16x16x32_bf16 v[124:127], v[204:207], v[20:23], v[124:127]
    ds_read_b64_tr_b16 v[196:197], v172 offset:49152
    ds_read_b64_tr_b16 v[198:199], v172 offset:51200
    s_waitcnt lgkmcnt(10)
    v_mfma_f32_16x16x32_bf16 v[68:71], v[208:211], v[16:19], v[68:71]
    ds_read_b64_tr_b16 v[200:201], v173 offset:49152
    ds_read_b64_tr_b16 v[202:203], v173 offset:51200
    v_mfma_f32_16x16x32_bf16 v[128:131], v[208:211], v[20:23], v[128:131]
    ds_read_b64_tr_b16 v[204:205], v174 offset:49152
    ds_read_b64_tr_b16 v[206:207], v174 offset:51200
    s_waitcnt lgkmcnt(12)
    v_mfma_f32_16x16x32_bf16 v[72:75], v[212:215], v[16:19], v[72:75]
    v_mfma_f32_16x16x32_bf16 v[132:135], v[212:215], v[20:23], v[132:135]
    s_waitcnt lgkmcnt(10)
    v_mfma_f32_16x16x32_bf16 v[76:79], v[216:219], v[16:19], v[76:79]
    v_mfma_f32_16x16x32_bf16 v[136:139], v[216:219], v[20:23], v[136:139]
    s_waitcnt lgkmcnt(0)
    s_barrier
    v_mfma_f32_16x16x32_bf16 v[80:83], v[220:223], v[16:19], v[80:83]
    ds_read_b64_tr_b16 v[208:209], v175 offset:0
    ds_read_b64_tr_b16 v[210:211], v175 offset:2048
    v_mfma_f32_16x16x32_bf16 v[140:143], v[220:223], v[20:23], v[140:143]
    v_mfma_f32_16x16x32_bf16 v[84:87], v[192:195], v[16:19], v[84:87]
    ds_read_b64_tr_b16 v[212:213], v176 offset:0
    ds_read_b64_tr_b16 v[214:215], v176 offset:2048
    v_mfma_f32_16x16x32_bf16 v[144:147], v[192:195], v[20:23], v[144:147]
    ds_read_b128 v[8:11], v4 offset:32768
    ds_read_b128 v[12:15], v4 offset:34816
    v_mfma_f32_16x16x32_bf16 v[88:91], v[196:199], v[16:19], v[88:91]
    ds_read_b64_tr_b16 v[216:217], v177 offset:0
    ds_read_b64_tr_b16 v[218:219], v177 offset:2048
    v_mfma_f32_16x16x32_bf16 v[148:151], v[196:199], v[20:23], v[148:151]
    v_mfma_f32_16x16x32_bf16 v[92:95], v[200:203], v[16:19], v[92:95]
    ds_read_b64_tr_b16 v[220:221], v178 offset:0
    ds_read_b64_tr_b16 v[222:223], v178 offset:2048
    v_mfma_f32_16x16x32_bf16 v[152:155], v[200:203], v[20:23], v[152:155]
    v_mfma_f32_16x16x32_bf16 v[96:99], v[204:207], v[16:19], v[96:99]
    ds_read_b64_tr_b16 v[192:193], v179 offset:0
    ds_read_b64_tr_b16 v[194:195], v179 offset:2048
    v_mfma_f32_16x16x32_bf16 v[156:159], v[204:207], v[20:23], v[156:159]
    s_waitcnt lgkmcnt(6)
    v_mfma_f32_16x16x32_bf16 v[40:43], v[208:211], v[8:11], v[40:43]
    ds_read_b64_tr_b16 v[196:197], v180 offset:0
    ds_read_b64_tr_b16 v[198:199], v180 offset:2048
    v_mfma_f32_16x16x32_bf16 v[100:103], v[208:211], v[12:15], v[100:103]
    s_waitcnt lgkmcnt(8)
    v_mfma_f32_16x16x32_bf16 v[44:47], v[212:215], v[8:11], v[44:47]
    ds_read_b64_tr_b16 v[200:201], v181 offset:0
    ds_read_b64_tr_b16 v[202:203], v181 offset:2048
    v_mfma_f32_16x16x32_bf16 v[104:107], v[212:215], v[12:15], v[104:107]
    s_waitcnt lgkmcnt(8)
    v_mfma_f32_16x16x32_bf16 v[48:51], v[216:219], v[8:11], v[48:51]
    ds_read_b64_tr_b16 v[204:205], v182 offset:0
    ds_read_b64_tr_b16 v[206:207], v182 offset:2048
    v_mfma_f32_16x16x32_bf16 v[108:111], v[216:219], v[12:15], v[108:111]
    ds_read_b128 v[16:19], v5 offset:32768
    ds_read_b128 v[20:23], v5 offset:34816
    s_waitcnt lgkmcnt(10)
    v_mfma_f32_16x16x32_bf16 v[52:55], v[220:223], v[8:11], v[52:55]
    ds_read_b64_tr_b16 v[208:209], v183 offset:0
    ds_read_b64_tr_b16 v[210:211], v183 offset:2048
    v_mfma_f32_16x16x32_bf16 v[112:115], v[220:223], v[12:15], v[112:115]
    s_waitcnt lgkmcnt(10)
    v_mfma_f32_16x16x32_bf16 v[56:59], v[192:195], v[8:11], v[56:59]
    ds_read_b64_tr_b16 v[212:213], v184 offset:0
    ds_read_b64_tr_b16 v[214:215], v184 offset:2048
    v_mfma_f32_16x16x32_bf16 v[116:119], v[192:195], v[12:15], v[116:119]
    s_waitcnt lgkmcnt(10)
    v_mfma_f32_16x16x32_bf16 v[60:63], v[196:199], v[8:11], v[60:63]
    ds_read_b64_tr_b16 v[216:217], v185 offset:0
    ds_read_b64_tr_b16 v[218:219], v185 offset:2048
    v_mfma_f32_16x16x32_bf16 v[120:123], v[196:199], v[12:15], v[120:123]
    s_waitcnt lgkmcnt(10)
    v_mfma_f32_16x16x32_bf16 v[64:67], v[200:203], v[8:11], v[64:67]
    ds_read_b64_tr_b16 v[220:221], v186 offset:0
    ds_read_b64_tr_b16 v[222:223], v186 offset:2048
    v_mfma_f32_16x16x32_bf16 v[124:127], v[200:203], v[12:15], v[124:127]
    s_waitcnt lgkmcnt(10)
    v_mfma_f32_16x16x32_bf16 v[68:71], v[204:207], v[8:11], v[68:71]
    ds_read_b64_tr_b16 v[192:193], v187 offset:0
    ds_read_b64_tr_b16 v[194:195], v187 offset:2048
    v_mfma_f32_16x16x32_bf16 v[128:131], v[204:207], v[12:15], v[128:131]
    s_waitcnt lgkmcnt(8)
    v_mfma_f32_16x16x32_bf16 v[72:75], v[208:211], v[8:11], v[72:75]
    ds_read_b64_tr_b16 v[196:197], v188 offset:0
    ds_read_b64_tr_b16 v[198:199], v188 offset:2048
    v_mfma_f32_16x16x32_bf16 v[132:135], v[208:211], v[12:15], v[132:135]
    s_waitcnt lgkmcnt(8)
    v_mfma_f32_16x16x32_bf16 v[76:79], v[212:215], v[8:11], v[76:79]
    ds_read_b64_tr_b16 v[200:201], v189 offset:0
    ds_read_b64_tr_b16 v[202:203], v189 offset:2048
    v_mfma_f32_16x16x32_bf16 v[136:139], v[212:215], v[12:15], v[136:139]
    s_waitcnt lgkmcnt(8)
    v_mfma_f32_16x16x32_bf16 v[80:83], v[216:219], v[8:11], v[80:83]
    ds_read_b64_tr_b16 v[204:205], v175 offset:16384
    ds_read_b64_tr_b16 v[206:207], v175 offset:18432
    v_mfma_f32_16x16x32_bf16 v[140:143], v[216:219], v[12:15], v[140:143]
    s_waitcnt lgkmcnt(8)
    v_mfma_f32_16x16x32_bf16 v[84:87], v[220:223], v[8:11], v[84:87]
    ds_read_b64_tr_b16 v[208:209], v176 offset:16384
    ds_read_b64_tr_b16 v[210:211], v176 offset:18432
    v_mfma_f32_16x16x32_bf16 v[144:147], v[220:223], v[12:15], v[144:147]
    s_waitcnt lgkmcnt(8)
    v_mfma_f32_16x16x32_bf16 v[88:91], v[192:195], v[8:11], v[88:91]
    ds_read_b64_tr_b16 v[212:213], v177 offset:16384
    ds_read_b64_tr_b16 v[214:215], v177 offset:18432
    v_mfma_f32_16x16x32_bf16 v[148:151], v[192:195], v[12:15], v[148:151]
    s_waitcnt lgkmcnt(8)
    v_mfma_f32_16x16x32_bf16 v[92:95], v[196:199], v[8:11], v[92:95]
    ds_read_b64_tr_b16 v[216:217], v178 offset:16384
    ds_read_b64_tr_b16 v[218:219], v178 offset:18432
    v_mfma_f32_16x16x32_bf16 v[152:155], v[196:199], v[12:15], v[152:155]
    s_waitcnt lgkmcnt(8)
    v_mfma_f32_16x16x32_bf16 v[96:99], v[200:203], v[8:11], v[96:99]
    ds_read_b64_tr_b16 v[220:221], v179 offset:16384
    ds_read_b64_tr_b16 v[222:223], v179 offset:18432
    v_mfma_f32_16x16x32_bf16 v[156:159], v[200:203], v[12:15], v[156:159]
    s_waitcnt lgkmcnt(8)
    v_mfma_f32_16x16x32_bf16 v[40:43], v[204:207], v[16:19], v[40:43]
    ds_read_b64_tr_b16 v[192:193], v180 offset:16384
    ds_read_b64_tr_b16 v[194:195], v180 offset:18432
    v_mfma_f32_16x16x32_bf16 v[100:103], v[204:207], v[20:23], v[100:103]
    s_waitcnt lgkmcnt(8)
    v_mfma_f32_16x16x32_bf16 v[44:47], v[208:211], v[16:19], v[44:47]
    ds_read_b64_tr_b16 v[196:197], v181 offset:16384
    ds_read_b64_tr_b16 v[198:199], v181 offset:18432
    v_mfma_f32_16x16x32_bf16 v[104:107], v[208:211], v[20:23], v[104:107]
    s_waitcnt lgkmcnt(8)
    v_mfma_f32_16x16x32_bf16 v[48:51], v[212:215], v[16:19], v[48:51]
    ds_read_b64_tr_b16 v[200:201], v182 offset:16384
    ds_read_b64_tr_b16 v[202:203], v182 offset:18432
    v_mfma_f32_16x16x32_bf16 v[108:111], v[212:215], v[20:23], v[108:111]
    s_waitcnt lgkmcnt(8)
    v_mfma_f32_16x16x32_bf16 v[52:55], v[216:219], v[16:19], v[52:55]
    ds_read_b64_tr_b16 v[204:205], v183 offset:16384
    ds_read_b64_tr_b16 v[206:207], v183 offset:18432
    v_mfma_f32_16x16x32_bf16 v[112:115], v[216:219], v[20:23], v[112:115]
    s_waitcnt lgkmcnt(8)
    v_mfma_f32_16x16x32_bf16 v[56:59], v[220:223], v[16:19], v[56:59]
    ds_read_b64_tr_b16 v[208:209], v184 offset:16384
    ds_read_b64_tr_b16 v[210:211], v184 offset:18432
    v_mfma_f32_16x16x32_bf16 v[116:119], v[220:223], v[20:23], v[116:119]
    s_waitcnt lgkmcnt(8)
    v_mfma_f32_16x16x32_bf16 v[60:63], v[192:195], v[16:19], v[60:63]
    ds_read_b64_tr_b16 v[212:213], v185 offset:16384
    ds_read_b64_tr_b16 v[214:215], v185 offset:18432
    v_mfma_f32_16x16x32_bf16 v[120:123], v[192:195], v[20:23], v[120:123]
    s_waitcnt lgkmcnt(8)
    v_mfma_f32_16x16x32_bf16 v[64:67], v[196:199], v[16:19], v[64:67]
    ds_read_b64_tr_b16 v[216:217], v186 offset:16384
    ds_read_b64_tr_b16 v[218:219], v186 offset:18432
    v_mfma_f32_16x16x32_bf16 v[124:127], v[196:199], v[20:23], v[124:127]
    ds_read_b64_tr_b16 v[220:221], v187 offset:16384
    ds_read_b64_tr_b16 v[222:223], v187 offset:18432
    s_waitcnt lgkmcnt(10)
    v_mfma_f32_16x16x32_bf16 v[68:71], v[200:203], v[16:19], v[68:71]
    ds_read_b64_tr_b16 v[192:193], v188 offset:16384
    ds_read_b64_tr_b16 v[194:195], v188 offset:18432
    v_mfma_f32_16x16x32_bf16 v[128:131], v[200:203], v[20:23], v[128:131]
    ds_read_b64_tr_b16 v[196:197], v189 offset:16384
    ds_read_b64_tr_b16 v[198:199], v189 offset:18432
    s_waitcnt lgkmcnt(12)
    v_mfma_f32_16x16x32_bf16 v[72:75], v[204:207], v[16:19], v[72:75]
    v_mfma_f32_16x16x32_bf16 v[132:135], v[204:207], v[20:23], v[132:135]
    s_waitcnt lgkmcnt(10)
    v_mfma_f32_16x16x32_bf16 v[76:79], v[208:211], v[16:19], v[76:79]
    v_mfma_f32_16x16x32_bf16 v[136:139], v[208:211], v[20:23], v[136:139]
    s_waitcnt lgkmcnt(0)
    s_barrier
    v_mfma_f32_16x16x32_bf16 v[80:83], v[212:215], v[16:19], v[80:83]
    ds_read_b64_tr_b16 v[200:201], v160 offset:0
    ds_read_b64_tr_b16 v[202:203], v160 offset:2048
    v_mfma_f32_16x16x32_bf16 v[140:143], v[212:215], v[20:23], v[140:143]
    v_mfma_f32_16x16x32_bf16 v[84:87], v[216:219], v[16:19], v[84:87]
    ds_read_b64_tr_b16 v[204:205], v161 offset:0
    ds_read_b64_tr_b16 v[206:207], v161 offset:2048
    v_mfma_f32_16x16x32_bf16 v[144:147], v[216:219], v[20:23], v[144:147]
    ds_read_b128 v[8:11], v4 offset:0
    ds_read_b128 v[12:15], v4 offset:2048
    v_mfma_f32_16x16x32_bf16 v[88:91], v[220:223], v[16:19], v[88:91]
    ds_read_b64_tr_b16 v[208:209], v162 offset:0
    ds_read_b64_tr_b16 v[210:211], v162 offset:2048
    v_mfma_f32_16x16x32_bf16 v[148:151], v[220:223], v[20:23], v[148:151]
    v_mfma_f32_16x16x32_bf16 v[92:95], v[192:195], v[16:19], v[92:95]
    ds_read_b64_tr_b16 v[212:213], v163 offset:0
    ds_read_b64_tr_b16 v[214:215], v163 offset:2048
    v_mfma_f32_16x16x32_bf16 v[152:155], v[192:195], v[20:23], v[152:155]
    v_mfma_f32_16x16x32_bf16 v[96:99], v[196:199], v[16:19], v[96:99]
    ds_read_b64_tr_b16 v[216:217], v164 offset:0
    ds_read_b64_tr_b16 v[218:219], v164 offset:2048
    v_mfma_f32_16x16x32_bf16 v[156:159], v[196:199], v[20:23], v[156:159]
    s_waitcnt lgkmcnt(6)
    v_mfma_f32_16x16x32_bf16 v[40:43], v[200:203], v[8:11], v[40:43]
    ds_read_b64_tr_b16 v[220:221], v165 offset:0
    ds_read_b64_tr_b16 v[222:223], v165 offset:2048
    v_mfma_f32_16x16x32_bf16 v[100:103], v[200:203], v[12:15], v[100:103]
    s_waitcnt lgkmcnt(8)
    v_mfma_f32_16x16x32_bf16 v[44:47], v[204:207], v[8:11], v[44:47]
    ds_read_b64_tr_b16 v[192:193], v166 offset:0
    ds_read_b64_tr_b16 v[194:195], v166 offset:2048
    v_mfma_f32_16x16x32_bf16 v[104:107], v[204:207], v[12:15], v[104:107]
    s_waitcnt lgkmcnt(8)
    v_mfma_f32_16x16x32_bf16 v[48:51], v[208:211], v[8:11], v[48:51]
    ds_read_b64_tr_b16 v[196:197], v167 offset:0
    ds_read_b64_tr_b16 v[198:199], v167 offset:2048
    v_mfma_f32_16x16x32_bf16 v[108:111], v[208:211], v[12:15], v[108:111]
    ds_read_b128 v[16:19], v5 offset:0
    ds_read_b128 v[20:23], v5 offset:2048
    s_waitcnt lgkmcnt(10)
    v_mfma_f32_16x16x32_bf16 v[52:55], v[212:215], v[8:11], v[52:55]
    ds_read_b64_tr_b16 v[200:201], v168 offset:0
    ds_read_b64_tr_b16 v[202:203], v168 offset:2048
    v_mfma_f32_16x16x32_bf16 v[112:115], v[212:215], v[12:15], v[112:115]
    s_waitcnt lgkmcnt(10)
    v_mfma_f32_16x16x32_bf16 v[56:59], v[216:219], v[8:11], v[56:59]
    ds_read_b64_tr_b16 v[204:205], v169 offset:0
    ds_read_b64_tr_b16 v[206:207], v169 offset:2048
    v_mfma_f32_16x16x32_bf16 v[116:119], v[216:219], v[12:15], v[116:119]
    s_waitcnt lgkmcnt(10)
    v_mfma_f32_16x16x32_bf16 v[60:63], v[220:223], v[8:11], v[60:63]
    ds_read_b64_tr_b16 v[208:209], v170 offset:0
    ds_read_b64_tr_b16 v[210:211], v170 offset:2048
    v_mfma_f32_16x16x32_bf16 v[120:123], v[220:223], v[12:15], v[120:123]
    s_waitcnt lgkmcnt(10)
    v_mfma_f32_16x16x32_bf16 v[64:67], v[192:195], v[8:11], v[64:67]
    ds_read_b64_tr_b16 v[212:213], v171 offset:0
    ds_read_b64_tr_b16 v[214:215], v171 offset:2048
    v_mfma_f32_16x16x32_bf16 v[124:127], v[192:195], v[12:15], v[124:127]
    s_waitcnt lgkmcnt(10)
    v_mfma_f32_16x16x32_bf16 v[68:71], v[196:199], v[8:11], v[68:71]
    ds_read_b64_tr_b16 v[216:217], v172 offset:0
    ds_read_b64_tr_b16 v[218:219], v172 offset:2048
    v_mfma_f32_16x16x32_bf16 v[128:131], v[196:199], v[12:15], v[128:131]
    s_waitcnt lgkmcnt(8)
    v_mfma_f32_16x16x32_bf16 v[72:75], v[200:203], v[8:11], v[72:75]
    ds_read_b64_tr_b16 v[220:221], v173 offset:0
    ds_read_b64_tr_b16 v[222:223], v173 offset:2048
    v_mfma_f32_16x16x32_bf16 v[132:135], v[200:203], v[12:15], v[132:135]
    s_waitcnt lgkmcnt(8)
    v_mfma_f32_16x16x32_bf16 v[76:79], v[204:207], v[8:11], v[76:79]
    ds_read_b64_tr_b16 v[192:193], v174 offset:0
    ds_read_b64_tr_b16 v[194:195], v174 offset:2048
    v_mfma_f32_16x16x32_bf16 v[136:139], v[204:207], v[12:15], v[136:139]
    s_waitcnt lgkmcnt(8)
    v_mfma_f32_16x16x32_bf16 v[80:83], v[208:211], v[8:11], v[80:83]
    ds_read_b64_tr_b16 v[196:197], v160 offset:16384
    ds_read_b64_tr_b16 v[198:199], v160 offset:18432
    v_mfma_f32_16x16x32_bf16 v[140:143], v[208:211], v[12:15], v[140:143]
    s_waitcnt lgkmcnt(8)
    v_mfma_f32_16x16x32_bf16 v[84:87], v[212:215], v[8:11], v[84:87]
    ds_read_b64_tr_b16 v[200:201], v161 offset:16384
    ds_read_b64_tr_b16 v[202:203], v161 offset:18432
    v_mfma_f32_16x16x32_bf16 v[144:147], v[212:215], v[12:15], v[144:147]
    s_waitcnt lgkmcnt(8)
    v_mfma_f32_16x16x32_bf16 v[88:91], v[216:219], v[8:11], v[88:91]
    ds_read_b64_tr_b16 v[204:205], v162 offset:16384
    ds_read_b64_tr_b16 v[206:207], v162 offset:18432
    v_mfma_f32_16x16x32_bf16 v[148:151], v[216:219], v[12:15], v[148:151]
    s_waitcnt lgkmcnt(8)
    v_mfma_f32_16x16x32_bf16 v[92:95], v[220:223], v[8:11], v[92:95]
    ds_read_b64_tr_b16 v[208:209], v163 offset:16384
    ds_read_b64_tr_b16 v[210:211], v163 offset:18432
    v_mfma_f32_16x16x32_bf16 v[152:155], v[220:223], v[12:15], v[152:155]
    s_waitcnt lgkmcnt(8)
    v_mfma_f32_16x16x32_bf16 v[96:99], v[192:195], v[8:11], v[96:99]
    ds_read_b64_tr_b16 v[212:213], v164 offset:16384
    ds_read_b64_tr_b16 v[214:215], v164 offset:18432
    v_mfma_f32_16x16x32_bf16 v[156:159], v[192:195], v[12:15], v[156:159]
    s_waitcnt lgkmcnt(8)
    v_mfma_f32_16x16x32_bf16 v[40:43], v[196:199], v[16:19], v[40:43]
    ds_read_b64_tr_b16 v[216:217], v165 offset:16384
    ds_read_b64_tr_b16 v[218:219], v165 offset:18432
    v_mfma_f32_16x16x32_bf16 v[100:103], v[196:199], v[20:23], v[100:103]
    s_waitcnt lgkmcnt(8)
    v_mfma_f32_16x16x32_bf16 v[44:47], v[200:203], v[16:19], v[44:47]
    ds_read_b64_tr_b16 v[220:221], v166 offset:16384
    ds_read_b64_tr_b16 v[222:223], v166 offset:18432
    v_mfma_f32_16x16x32_bf16 v[104:107], v[200:203], v[20:23], v[104:107]
    s_waitcnt lgkmcnt(8)
    v_mfma_f32_16x16x32_bf16 v[48:51], v[204:207], v[16:19], v[48:51]
    ds_read_b64_tr_b16 v[192:193], v167 offset:16384
    ds_read_b64_tr_b16 v[194:195], v167 offset:18432
    v_mfma_f32_16x16x32_bf16 v[108:111], v[204:207], v[20:23], v[108:111]
    s_waitcnt lgkmcnt(8)
    v_mfma_f32_16x16x32_bf16 v[52:55], v[208:211], v[16:19], v[52:55]
    ds_read_b64_tr_b16 v[196:197], v168 offset:16384
    ds_read_b64_tr_b16 v[198:199], v168 offset:18432
    v_mfma_f32_16x16x32_bf16 v[112:115], v[208:211], v[20:23], v[112:115]
    s_waitcnt lgkmcnt(8)
    v_mfma_f32_16x16x32_bf16 v[56:59], v[212:215], v[16:19], v[56:59]
    ds_read_b64_tr_b16 v[200:201], v169 offset:16384
    ds_read_b64_tr_b16 v[202:203], v169 offset:18432
    v_mfma_f32_16x16x32_bf16 v[116:119], v[212:215], v[20:23], v[116:119]
    s_waitcnt lgkmcnt(8)
    v_mfma_f32_16x16x32_bf16 v[60:63], v[216:219], v[16:19], v[60:63]
    ds_read_b64_tr_b16 v[204:205], v170 offset:16384
    ds_read_b64_tr_b16 v[206:207], v170 offset:18432
    v_mfma_f32_16x16x32_bf16 v[120:123], v[216:219], v[20:23], v[120:123]
    s_waitcnt lgkmcnt(8)
    v_mfma_f32_16x16x32_bf16 v[64:67], v[220:223], v[16:19], v[64:67]
    ds_read_b64_tr_b16 v[208:209], v171 offset:16384
    ds_read_b64_tr_b16 v[210:211], v171 offset:18432
    v_mfma_f32_16x16x32_bf16 v[124:127], v[220:223], v[20:23], v[124:127]
    ds_read_b64_tr_b16 v[212:213], v172 offset:16384
    ds_read_b64_tr_b16 v[214:215], v172 offset:18432
    s_waitcnt lgkmcnt(10)
    v_mfma_f32_16x16x32_bf16 v[68:71], v[192:195], v[16:19], v[68:71]
    ds_read_b64_tr_b16 v[216:217], v173 offset:16384
    ds_read_b64_tr_b16 v[218:219], v173 offset:18432
    v_mfma_f32_16x16x32_bf16 v[128:131], v[192:195], v[20:23], v[128:131]
    ds_read_b64_tr_b16 v[220:221], v174 offset:16384
    ds_read_b64_tr_b16 v[222:223], v174 offset:18432
    s_waitcnt lgkmcnt(12)
    v_mfma_f32_16x16x32_bf16 v[72:75], v[196:199], v[16:19], v[72:75]
    v_mfma_f32_16x16x32_bf16 v[132:135], v[196:199], v[20:23], v[132:135]
    s_waitcnt lgkmcnt(10)
    v_mfma_f32_16x16x32_bf16 v[76:79], v[200:203], v[16:19], v[76:79]
    v_mfma_f32_16x16x32_bf16 v[136:139], v[200:203], v[20:23], v[136:139]
    s_waitcnt lgkmcnt(0)
    s_barrier
    v_mfma_f32_16x16x32_bf16 v[80:83], v[204:207], v[16:19], v[80:83]
    ds_read_b64_tr_b16 v[192:193], v160 offset:32768
    ds_read_b64_tr_b16 v[194:195], v160 offset:34816
    v_mfma_f32_16x16x32_bf16 v[140:143], v[204:207], v[20:23], v[140:143]
    v_mfma_f32_16x16x32_bf16 v[84:87], v[208:211], v[16:19], v[84:87]
    ds_read_b64_tr_b16 v[196:197], v161 offset:32768
    ds_read_b64_tr_b16 v[198:199], v161 offset:34816
    v_mfma_f32_16x16x32_bf16 v[144:147], v[208:211], v[20:23], v[144:147]
    ds_read_b128 v[8:11], v4 offset:16384
    ds_read_b128 v[12:15], v4 offset:18432
    v_mfma_f32_16x16x32_bf16 v[88:91], v[212:215], v[16:19], v[88:91]
    ds_read_b64_tr_b16 v[200:201], v162 offset:32768
    ds_read_b64_tr_b16 v[202:203], v162 offset:34816
    v_mfma_f32_16x16x32_bf16 v[148:151], v[212:215], v[20:23], v[148:151]
    v_mfma_f32_16x16x32_bf16 v[92:95], v[216:219], v[16:19], v[92:95]
    ds_read_b64_tr_b16 v[204:205], v163 offset:32768
    ds_read_b64_tr_b16 v[206:207], v163 offset:34816
    v_mfma_f32_16x16x32_bf16 v[152:155], v[216:219], v[20:23], v[152:155]
    v_mfma_f32_16x16x32_bf16 v[96:99], v[220:223], v[16:19], v[96:99]
    ds_read_b64_tr_b16 v[208:209], v164 offset:32768
    ds_read_b64_tr_b16 v[210:211], v164 offset:34816
    v_mfma_f32_16x16x32_bf16 v[156:159], v[220:223], v[20:23], v[156:159]
    s_waitcnt lgkmcnt(6)
    v_mfma_f32_16x16x32_bf16 v[40:43], v[192:195], v[8:11], v[40:43]
    ds_read_b64_tr_b16 v[212:213], v165 offset:32768
    ds_read_b64_tr_b16 v[214:215], v165 offset:34816
    v_mfma_f32_16x16x32_bf16 v[100:103], v[192:195], v[12:15], v[100:103]
    s_waitcnt lgkmcnt(8)
    v_mfma_f32_16x16x32_bf16 v[44:47], v[196:199], v[8:11], v[44:47]
    ds_read_b64_tr_b16 v[216:217], v166 offset:32768
    ds_read_b64_tr_b16 v[218:219], v166 offset:34816
    v_mfma_f32_16x16x32_bf16 v[104:107], v[196:199], v[12:15], v[104:107]
    s_waitcnt lgkmcnt(8)
    v_mfma_f32_16x16x32_bf16 v[48:51], v[200:203], v[8:11], v[48:51]
    ds_read_b64_tr_b16 v[220:221], v167 offset:32768
    ds_read_b64_tr_b16 v[222:223], v167 offset:34816
    v_mfma_f32_16x16x32_bf16 v[108:111], v[200:203], v[12:15], v[108:111]
    ds_read_b128 v[16:19], v5 offset:16384
    ds_read_b128 v[20:23], v5 offset:18432
    s_waitcnt lgkmcnt(10)
    v_mfma_f32_16x16x32_bf16 v[52:55], v[204:207], v[8:11], v[52:55]
    ds_read_b64_tr_b16 v[192:193], v168 offset:32768
    ds_read_b64_tr_b16 v[194:195], v168 offset:34816
    v_mfma_f32_16x16x32_bf16 v[112:115], v[204:207], v[12:15], v[112:115]
    s_waitcnt lgkmcnt(10)
    v_mfma_f32_16x16x32_bf16 v[56:59], v[208:211], v[8:11], v[56:59]
    ds_read_b64_tr_b16 v[196:197], v169 offset:32768
    ds_read_b64_tr_b16 v[198:199], v169 offset:34816
    v_mfma_f32_16x16x32_bf16 v[116:119], v[208:211], v[12:15], v[116:119]
    s_waitcnt lgkmcnt(10)
    v_mfma_f32_16x16x32_bf16 v[60:63], v[212:215], v[8:11], v[60:63]
    ds_read_b64_tr_b16 v[200:201], v170 offset:32768
    ds_read_b64_tr_b16 v[202:203], v170 offset:34816
    v_mfma_f32_16x16x32_bf16 v[120:123], v[212:215], v[12:15], v[120:123]
    s_waitcnt lgkmcnt(10)
    v_mfma_f32_16x16x32_bf16 v[64:67], v[216:219], v[8:11], v[64:67]
    ds_read_b64_tr_b16 v[204:205], v171 offset:32768
    ds_read_b64_tr_b16 v[206:207], v171 offset:34816
    v_mfma_f32_16x16x32_bf16 v[124:127], v[216:219], v[12:15], v[124:127]
    s_waitcnt lgkmcnt(10)
    v_mfma_f32_16x16x32_bf16 v[68:71], v[220:223], v[8:11], v[68:71]
    ds_read_b64_tr_b16 v[208:209], v172 offset:32768
    ds_read_b64_tr_b16 v[210:211], v172 offset:34816
    v_mfma_f32_16x16x32_bf16 v[128:131], v[220:223], v[12:15], v[128:131]
    s_waitcnt lgkmcnt(8)
    v_mfma_f32_16x16x32_bf16 v[72:75], v[192:195], v[8:11], v[72:75]
    ds_read_b64_tr_b16 v[212:213], v173 offset:32768
    ds_read_b64_tr_b16 v[214:215], v173 offset:34816
    v_mfma_f32_16x16x32_bf16 v[132:135], v[192:195], v[12:15], v[132:135]
    s_waitcnt lgkmcnt(8)
    v_mfma_f32_16x16x32_bf16 v[76:79], v[196:199], v[8:11], v[76:79]
    ds_read_b64_tr_b16 v[216:217], v174 offset:32768
    ds_read_b64_tr_b16 v[218:219], v174 offset:34816
    v_mfma_f32_16x16x32_bf16 v[136:139], v[196:199], v[12:15], v[136:139]
    s_waitcnt lgkmcnt(8)
    v_mfma_f32_16x16x32_bf16 v[80:83], v[200:203], v[8:11], v[80:83]
    ds_read_b64_tr_b16 v[220:221], v160 offset:49152
    ds_read_b64_tr_b16 v[222:223], v160 offset:51200
    v_mfma_f32_16x16x32_bf16 v[140:143], v[200:203], v[12:15], v[140:143]
    s_waitcnt lgkmcnt(8)
    v_mfma_f32_16x16x32_bf16 v[84:87], v[204:207], v[8:11], v[84:87]
    ds_read_b64_tr_b16 v[192:193], v161 offset:49152
    ds_read_b64_tr_b16 v[194:195], v161 offset:51200
    v_mfma_f32_16x16x32_bf16 v[144:147], v[204:207], v[12:15], v[144:147]
    s_waitcnt lgkmcnt(8)
    v_mfma_f32_16x16x32_bf16 v[88:91], v[208:211], v[8:11], v[88:91]
    ds_read_b64_tr_b16 v[196:197], v162 offset:49152
    ds_read_b64_tr_b16 v[198:199], v162 offset:51200
    v_mfma_f32_16x16x32_bf16 v[148:151], v[208:211], v[12:15], v[148:151]
    s_waitcnt lgkmcnt(8)
    v_mfma_f32_16x16x32_bf16 v[92:95], v[212:215], v[8:11], v[92:95]
    ds_read_b64_tr_b16 v[200:201], v163 offset:49152
    ds_read_b64_tr_b16 v[202:203], v163 offset:51200
    v_mfma_f32_16x16x32_bf16 v[152:155], v[212:215], v[12:15], v[152:155]
    s_waitcnt lgkmcnt(8)
    v_mfma_f32_16x16x32_bf16 v[96:99], v[216:219], v[8:11], v[96:99]
    ds_read_b64_tr_b16 v[204:205], v164 offset:49152
    ds_read_b64_tr_b16 v[206:207], v164 offset:51200
    v_mfma_f32_16x16x32_bf16 v[156:159], v[216:219], v[12:15], v[156:159]
    s_waitcnt lgkmcnt(8)
    v_mfma_f32_16x16x32_bf16 v[40:43], v[220:223], v[16:19], v[40:43]
    ds_read_b64_tr_b16 v[208:209], v165 offset:49152
    ds_read_b64_tr_b16 v[210:211], v165 offset:51200
    v_mfma_f32_16x16x32_bf16 v[100:103], v[220:223], v[20:23], v[100:103]
    s_waitcnt lgkmcnt(8)
    v_mfma_f32_16x16x32_bf16 v[44:47], v[192:195], v[16:19], v[44:47]
    ds_read_b64_tr_b16 v[212:213], v166 offset:49152
    ds_read_b64_tr_b16 v[214:215], v166 offset:51200
    v_mfma_f32_16x16x32_bf16 v[104:107], v[192:195], v[20:23], v[104:107]
    s_waitcnt lgkmcnt(8)
    v_mfma_f32_16x16x32_bf16 v[48:51], v[196:199], v[16:19], v[48:51]
    ds_read_b64_tr_b16 v[216:217], v167 offset:49152
    ds_read_b64_tr_b16 v[218:219], v167 offset:51200
    v_mfma_f32_16x16x32_bf16 v[108:111], v[196:199], v[20:23], v[108:111]
    s_waitcnt lgkmcnt(8)
    v_mfma_f32_16x16x32_bf16 v[52:55], v[200:203], v[16:19], v[52:55]
    ds_read_b64_tr_b16 v[220:221], v168 offset:49152
    ds_read_b64_tr_b16 v[222:223], v168 offset:51200
    v_mfma_f32_16x16x32_bf16 v[112:115], v[200:203], v[20:23], v[112:115]
    s_waitcnt lgkmcnt(8)
    v_mfma_f32_16x16x32_bf16 v[56:59], v[204:207], v[16:19], v[56:59]
    ds_read_b64_tr_b16 v[192:193], v169 offset:49152
    ds_read_b64_tr_b16 v[194:195], v169 offset:51200
    v_mfma_f32_16x16x32_bf16 v[116:119], v[204:207], v[20:23], v[116:119]
    s_waitcnt lgkmcnt(8)
    v_mfma_f32_16x16x32_bf16 v[60:63], v[208:211], v[16:19], v[60:63]
    ds_read_b64_tr_b16 v[196:197], v170 offset:49152
    ds_read_b64_tr_b16 v[198:199], v170 offset:51200
    v_mfma_f32_16x16x32_bf16 v[120:123], v[208:211], v[20:23], v[120:123]
    s_waitcnt lgkmcnt(8)
    v_mfma_f32_16x16x32_bf16 v[64:67], v[212:215], v[16:19], v[64:67]
    ds_read_b64_tr_b16 v[200:201], v171 offset:49152
    ds_read_b64_tr_b16 v[202:203], v171 offset:51200
    v_mfma_f32_16x16x32_bf16 v[124:127], v[212:215], v[20:23], v[124:127]
    ds_read_b64_tr_b16 v[204:205], v172 offset:49152
    ds_read_b64_tr_b16 v[206:207], v172 offset:51200
    s_waitcnt lgkmcnt(10)
    v_mfma_f32_16x16x32_bf16 v[68:71], v[216:219], v[16:19], v[68:71]
    ds_read_b64_tr_b16 v[208:209], v173 offset:49152
    ds_read_b64_tr_b16 v[210:211], v173 offset:51200
    v_mfma_f32_16x16x32_bf16 v[128:131], v[216:219], v[20:23], v[128:131]
    ds_read_b64_tr_b16 v[212:213], v174 offset:49152
    ds_read_b64_tr_b16 v[214:215], v174 offset:51200
    s_waitcnt lgkmcnt(12)
    v_mfma_f32_16x16x32_bf16 v[72:75], v[220:223], v[16:19], v[72:75]
    v_mfma_f32_16x16x32_bf16 v[132:135], v[220:223], v[20:23], v[132:135]
    s_waitcnt lgkmcnt(10)
    v_mfma_f32_16x16x32_bf16 v[76:79], v[192:195], v[16:19], v[76:79]
    v_mfma_f32_16x16x32_bf16 v[136:139], v[192:195], v[20:23], v[136:139]
    s_waitcnt lgkmcnt(0)
    s_barrier
    v_mfma_f32_16x16x32_bf16 v[80:83], v[196:199], v[16:19], v[80:83]
    ds_read_b64_tr_b16 v[216:217], v175 offset:0
    ds_read_b64_tr_b16 v[218:219], v175 offset:2048
    v_mfma_f32_16x16x32_bf16 v[140:143], v[196:199], v[20:23], v[140:143]
    v_mfma_f32_16x16x32_bf16 v[84:87], v[200:203], v[16:19], v[84:87]
    ds_read_b64_tr_b16 v[220:221], v176 offset:0
    ds_read_b64_tr_b16 v[222:223], v176 offset:2048
    v_mfma_f32_16x16x32_bf16 v[144:147], v[200:203], v[20:23], v[144:147]
    ds_read_b128 v[8:11], v4 offset:32768
    ds_read_b128 v[12:15], v4 offset:34816
    v_mfma_f32_16x16x32_bf16 v[88:91], v[204:207], v[16:19], v[88:91]
    ds_read_b64_tr_b16 v[192:193], v177 offset:0
    ds_read_b64_tr_b16 v[194:195], v177 offset:2048
    v_mfma_f32_16x16x32_bf16 v[148:151], v[204:207], v[20:23], v[148:151]
    v_mfma_f32_16x16x32_bf16 v[92:95], v[208:211], v[16:19], v[92:95]
    ds_read_b64_tr_b16 v[196:197], v178 offset:0
    ds_read_b64_tr_b16 v[198:199], v178 offset:2048
    v_mfma_f32_16x16x32_bf16 v[152:155], v[208:211], v[20:23], v[152:155]
    v_mfma_f32_16x16x32_bf16 v[96:99], v[212:215], v[16:19], v[96:99]
    ds_read_b64_tr_b16 v[200:201], v179 offset:0
    ds_read_b64_tr_b16 v[202:203], v179 offset:2048
    v_mfma_f32_16x16x32_bf16 v[156:159], v[212:215], v[20:23], v[156:159]
    s_waitcnt lgkmcnt(6)
    v_mfma_f32_16x16x32_bf16 v[40:43], v[216:219], v[8:11], v[40:43]
    ds_read_b64_tr_b16 v[204:205], v180 offset:0
    ds_read_b64_tr_b16 v[206:207], v180 offset:2048
    v_mfma_f32_16x16x32_bf16 v[100:103], v[216:219], v[12:15], v[100:103]
    s_waitcnt lgkmcnt(8)
    v_mfma_f32_16x16x32_bf16 v[44:47], v[220:223], v[8:11], v[44:47]
    ds_read_b64_tr_b16 v[208:209], v181 offset:0
    ds_read_b64_tr_b16 v[210:211], v181 offset:2048
    v_mfma_f32_16x16x32_bf16 v[104:107], v[220:223], v[12:15], v[104:107]
    s_waitcnt lgkmcnt(8)
    v_mfma_f32_16x16x32_bf16 v[48:51], v[192:195], v[8:11], v[48:51]
    ds_read_b64_tr_b16 v[212:213], v182 offset:0
    ds_read_b64_tr_b16 v[214:215], v182 offset:2048
    v_mfma_f32_16x16x32_bf16 v[108:111], v[192:195], v[12:15], v[108:111]
    ds_read_b128 v[16:19], v5 offset:32768
    ds_read_b128 v[20:23], v5 offset:34816
    s_waitcnt lgkmcnt(10)
    v_mfma_f32_16x16x32_bf16 v[52:55], v[196:199], v[8:11], v[52:55]
    ds_read_b64_tr_b16 v[216:217], v183 offset:0
    ds_read_b64_tr_b16 v[218:219], v183 offset:2048
    v_mfma_f32_16x16x32_bf16 v[112:115], v[196:199], v[12:15], v[112:115]
    s_waitcnt lgkmcnt(10)
    v_mfma_f32_16x16x32_bf16 v[56:59], v[200:203], v[8:11], v[56:59]
    ds_read_b64_tr_b16 v[220:221], v184 offset:0
    ds_read_b64_tr_b16 v[222:223], v184 offset:2048
    v_mfma_f32_16x16x32_bf16 v[116:119], v[200:203], v[12:15], v[116:119]
    s_waitcnt lgkmcnt(10)
    v_mfma_f32_16x16x32_bf16 v[60:63], v[204:207], v[8:11], v[60:63]
    ds_read_b64_tr_b16 v[192:193], v185 offset:0
    ds_read_b64_tr_b16 v[194:195], v185 offset:2048
    v_mfma_f32_16x16x32_bf16 v[120:123], v[204:207], v[12:15], v[120:123]
    s_waitcnt lgkmcnt(10)
    v_mfma_f32_16x16x32_bf16 v[64:67], v[208:211], v[8:11], v[64:67]
    ds_read_b64_tr_b16 v[196:197], v186 offset:0
    ds_read_b64_tr_b16 v[198:199], v186 offset:2048
    v_mfma_f32_16x16x32_bf16 v[124:127], v[208:211], v[12:15], v[124:127]
    s_waitcnt lgkmcnt(10)
    v_mfma_f32_16x16x32_bf16 v[68:71], v[212:215], v[8:11], v[68:71]
    ds_read_b64_tr_b16 v[200:201], v187 offset:0
    ds_read_b64_tr_b16 v[202:203], v187 offset:2048
    v_mfma_f32_16x16x32_bf16 v[128:131], v[212:215], v[12:15], v[128:131]
    s_waitcnt lgkmcnt(8)
    v_mfma_f32_16x16x32_bf16 v[72:75], v[216:219], v[8:11], v[72:75]
    ds_read_b64_tr_b16 v[204:205], v188 offset:0
    ds_read_b64_tr_b16 v[206:207], v188 offset:2048
    v_mfma_f32_16x16x32_bf16 v[132:135], v[216:219], v[12:15], v[132:135]
    s_waitcnt lgkmcnt(8)
    v_mfma_f32_16x16x32_bf16 v[76:79], v[220:223], v[8:11], v[76:79]
    ds_read_b64_tr_b16 v[208:209], v189 offset:0
    ds_read_b64_tr_b16 v[210:211], v189 offset:2048
    v_mfma_f32_16x16x32_bf16 v[136:139], v[220:223], v[12:15], v[136:139]
    s_waitcnt lgkmcnt(8)
    v_mfma_f32_16x16x32_bf16 v[80:83], v[192:195], v[8:11], v[80:83]
    ds_read_b64_tr_b16 v[212:213], v175 offset:16384
    ds_read_b64_tr_b16 v[214:215], v175 offset:18432
    v_mfma_f32_16x16x32_bf16 v[140:143], v[192:195], v[12:15], v[140:143]
    s_waitcnt lgkmcnt(8)
    v_mfma_f32_16x16x32_bf16 v[84:87], v[196:199], v[8:11], v[84:87]
    ds_read_b64_tr_b16 v[216:217], v176 offset:16384
    ds_read_b64_tr_b16 v[218:219], v176 offset:18432
    v_mfma_f32_16x16x32_bf16 v[144:147], v[196:199], v[12:15], v[144:147]
    s_waitcnt lgkmcnt(8)
    v_mfma_f32_16x16x32_bf16 v[88:91], v[200:203], v[8:11], v[88:91]
    ds_read_b64_tr_b16 v[220:221], v177 offset:16384
    ds_read_b64_tr_b16 v[222:223], v177 offset:18432
    v_mfma_f32_16x16x32_bf16 v[148:151], v[200:203], v[12:15], v[148:151]
    s_waitcnt lgkmcnt(8)
    v_mfma_f32_16x16x32_bf16 v[92:95], v[204:207], v[8:11], v[92:95]
    ds_read_b64_tr_b16 v[192:193], v178 offset:16384
    ds_read_b64_tr_b16 v[194:195], v178 offset:18432
    v_mfma_f32_16x16x32_bf16 v[152:155], v[204:207], v[12:15], v[152:155]
    s_waitcnt lgkmcnt(8)
    v_mfma_f32_16x16x32_bf16 v[96:99], v[208:211], v[8:11], v[96:99]
    ds_read_b64_tr_b16 v[196:197], v179 offset:16384
    ds_read_b64_tr_b16 v[198:199], v179 offset:18432
    v_mfma_f32_16x16x32_bf16 v[156:159], v[208:211], v[12:15], v[156:159]
    s_waitcnt lgkmcnt(8)
    v_mfma_f32_16x16x32_bf16 v[40:43], v[212:215], v[16:19], v[40:43]
    ds_read_b64_tr_b16 v[200:201], v180 offset:16384
    ds_read_b64_tr_b16 v[202:203], v180 offset:18432
    v_mfma_f32_16x16x32_bf16 v[100:103], v[212:215], v[20:23], v[100:103]
    s_waitcnt lgkmcnt(8)
    v_mfma_f32_16x16x32_bf16 v[44:47], v[216:219], v[16:19], v[44:47]
    ds_read_b64_tr_b16 v[204:205], v181 offset:16384
    ds_read_b64_tr_b16 v[206:207], v181 offset:18432
    v_mfma_f32_16x16x32_bf16 v[104:107], v[216:219], v[20:23], v[104:107]
    s_waitcnt lgkmcnt(8)
    v_mfma_f32_16x16x32_bf16 v[48:51], v[220:223], v[16:19], v[48:51]
    ds_read_b64_tr_b16 v[208:209], v182 offset:16384
    ds_read_b64_tr_b16 v[210:211], v182 offset:18432
    v_mfma_f32_16x16x32_bf16 v[108:111], v[220:223], v[20:23], v[108:111]
    s_waitcnt lgkmcnt(8)
    v_mfma_f32_16x16x32_bf16 v[52:55], v[192:195], v[16:19], v[52:55]
    ds_read_b64_tr_b16 v[212:213], v183 offset:16384
    ds_read_b64_tr_b16 v[214:215], v183 offset:18432
    v_mfma_f32_16x16x32_bf16 v[112:115], v[192:195], v[20:23], v[112:115]
    s_waitcnt lgkmcnt(8)
    v_mfma_f32_16x16x32_bf16 v[56:59], v[196:199], v[16:19], v[56:59]
    ds_read_b64_tr_b16 v[216:217], v184 offset:16384
    ds_read_b64_tr_b16 v[218:219], v184 offset:18432
    v_mfma_f32_16x16x32_bf16 v[116:119], v[196:199], v[20:23], v[116:119]
    s_waitcnt lgkmcnt(8)
    v_mfma_f32_16x16x32_bf16 v[60:63], v[200:203], v[16:19], v[60:63]
    ds_read_b64_tr_b16 v[220:221], v185 offset:16384
    ds_read_b64_tr_b16 v[222:223], v185 offset:18432
    v_mfma_f32_16x16x32_bf16 v[120:123], v[200:203], v[20:23], v[120:123]
    s_waitcnt lgkmcnt(8)
    v_mfma_f32_16x16x32_bf16 v[64:67], v[204:207], v[16:19], v[64:67]
    ds_read_b64_tr_b16 v[192:193], v186 offset:16384
    ds_read_b64_tr_b16 v[194:195], v186 offset:18432
    v_mfma_f32_16x16x32_bf16 v[124:127], v[204:207], v[20:23], v[124:127]
    ds_read_b64_tr_b16 v[196:197], v187 offset:16384
    ds_read_b64_tr_b16 v[198:199], v187 offset:18432
    s_waitcnt lgkmcnt(10)
    v_mfma_f32_16x16x32_bf16 v[68:71], v[208:211], v[16:19], v[68:71]
    ds_read_b64_tr_b16 v[200:201], v188 offset:16384
    ds_read_b64_tr_b16 v[202:203], v188 offset:18432
    v_mfma_f32_16x16x32_bf16 v[128:131], v[208:211], v[20:23], v[128:131]
    ds_read_b64_tr_b16 v[204:205], v189 offset:16384
    ds_read_b64_tr_b16 v[206:207], v189 offset:18432
    s_waitcnt lgkmcnt(12)
    v_mfma_f32_16x16x32_bf16 v[72:75], v[212:215], v[16:19], v[72:75]
    v_mfma_f32_16x16x32_bf16 v[132:135], v[212:215], v[20:23], v[132:135]
    s_waitcnt lgkmcnt(10)
    v_mfma_f32_16x16x32_bf16 v[76:79], v[216:219], v[16:19], v[76:79]
    v_mfma_f32_16x16x32_bf16 v[136:139], v[216:219], v[20:23], v[136:139]
    s_waitcnt lgkmcnt(0)
    s_barrier
    v_mfma_f32_16x16x32_bf16 v[80:83], v[220:223], v[16:19], v[80:83]
    ds_read_b64_tr_b16 v[208:209], v160 offset:0
    ds_read_b64_tr_b16 v[210:211], v160 offset:2048
    v_mfma_f32_16x16x32_bf16 v[140:143], v[220:223], v[20:23], v[140:143]
    v_mfma_f32_16x16x32_bf16 v[84:87], v[192:195], v[16:19], v[84:87]
    ds_read_b64_tr_b16 v[212:213], v161 offset:0
    ds_read_b64_tr_b16 v[214:215], v161 offset:2048
    v_mfma_f32_16x16x32_bf16 v[144:147], v[192:195], v[20:23], v[144:147]
    ds_read_b128 v[8:11], v4 offset:0
    ds_read_b128 v[12:15], v4 offset:2048
    v_mfma_f32_16x16x32_bf16 v[88:91], v[196:199], v[16:19], v[88:91]
    ds_read_b64_tr_b16 v[216:217], v162 offset:0
    ds_read_b64_tr_b16 v[218:219], v162 offset:2048
    v_mfma_f32_16x16x32_bf16 v[148:151], v[196:199], v[20:23], v[148:151]
    v_mfma_f32_16x16x32_bf16 v[92:95], v[200:203], v[16:19], v[92:95]
    ds_read_b64_tr_b16 v[220:221], v163 offset:0
    ds_read_b64_tr_b16 v[222:223], v163 offset:2048
    v_mfma_f32_16x16x32_bf16 v[152:155], v[200:203], v[20:23], v[152:155]
    v_mfma_f32_16x16x32_bf16 v[96:99], v[204:207], v[16:19], v[96:99]
    ds_read_b64_tr_b16 v[192:193], v164 offset:0
    ds_read_b64_tr_b16 v[194:195], v164 offset:2048
    v_mfma_f32_16x16x32_bf16 v[156:159], v[204:207], v[20:23], v[156:159]
    s_waitcnt lgkmcnt(6)
    v_mfma_f32_16x16x32_bf16 v[40:43], v[208:211], v[8:11], v[40:43]
    ds_read_b64_tr_b16 v[196:197], v165 offset:0
    ds_read_b64_tr_b16 v[198:199], v165 offset:2048
    v_mfma_f32_16x16x32_bf16 v[100:103], v[208:211], v[12:15], v[100:103]
    s_waitcnt lgkmcnt(8)
    v_mfma_f32_16x16x32_bf16 v[44:47], v[212:215], v[8:11], v[44:47]
    ds_read_b64_tr_b16 v[200:201], v166 offset:0
    ds_read_b64_tr_b16 v[202:203], v166 offset:2048
    v_mfma_f32_16x16x32_bf16 v[104:107], v[212:215], v[12:15], v[104:107]
    s_waitcnt lgkmcnt(8)
    v_mfma_f32_16x16x32_bf16 v[48:51], v[216:219], v[8:11], v[48:51]
    ds_read_b64_tr_b16 v[204:205], v167 offset:0
    ds_read_b64_tr_b16 v[206:207], v167 offset:2048
    v_mfma_f32_16x16x32_bf16 v[108:111], v[216:219], v[12:15], v[108:111]
    ds_read_b128 v[16:19], v5 offset:0
    ds_read_b128 v[20:23], v5 offset:2048
    s_waitcnt lgkmcnt(10)
    v_mfma_f32_16x16x32_bf16 v[52:55], v[220:223], v[8:11], v[52:55]
    ds_read_b64_tr_b16 v[208:209], v168 offset:0
    ds_read_b64_tr_b16 v[210:211], v168 offset:2048
    v_mfma_f32_16x16x32_bf16 v[112:115], v[220:223], v[12:15], v[112:115]
    s_waitcnt lgkmcnt(10)
    v_mfma_f32_16x16x32_bf16 v[56:59], v[192:195], v[8:11], v[56:59]
    ds_read_b64_tr_b16 v[212:213], v169 offset:0
    ds_read_b64_tr_b16 v[214:215], v169 offset:2048
    v_mfma_f32_16x16x32_bf16 v[116:119], v[192:195], v[12:15], v[116:119]
    s_waitcnt lgkmcnt(10)
    v_mfma_f32_16x16x32_bf16 v[60:63], v[196:199], v[8:11], v[60:63]
    ds_read_b64_tr_b16 v[216:217], v170 offset:0
    ds_read_b64_tr_b16 v[218:219], v170 offset:2048
    v_mfma_f32_16x16x32_bf16 v[120:123], v[196:199], v[12:15], v[120:123]
    s_waitcnt lgkmcnt(10)
    v_mfma_f32_16x16x32_bf16 v[64:67], v[200:203], v[8:11], v[64:67]
    ds_read_b64_tr_b16 v[220:221], v171 offset:0
    ds_read_b64_tr_b16 v[222:223], v171 offset:2048
    v_mfma_f32_16x16x32_bf16 v[124:127], v[200:203], v[12:15], v[124:127]
    s_waitcnt lgkmcnt(10)
    v_mfma_f32_16x16x32_bf16 v[68:71], v[204:207], v[8:11], v[68:71]
    ds_read_b64_tr_b16 v[192:193], v172 offset:0
    ds_read_b64_tr_b16 v[194:195], v172 offset:2048
    v_mfma_f32_16x16x32_bf16 v[128:131], v[204:207], v[12:15], v[128:131]
    s_waitcnt lgkmcnt(8)
    v_mfma_f32_16x16x32_bf16 v[72:75], v[208:211], v[8:11], v[72:75]
    ds_read_b64_tr_b16 v[196:197], v173 offset:0
    ds_read_b64_tr_b16 v[198:199], v173 offset:2048
    v_mfma_f32_16x16x32_bf16 v[132:135], v[208:211], v[12:15], v[132:135]
    s_waitcnt lgkmcnt(8)
    v_mfma_f32_16x16x32_bf16 v[76:79], v[212:215], v[8:11], v[76:79]
    ds_read_b64_tr_b16 v[200:201], v174 offset:0
    ds_read_b64_tr_b16 v[202:203], v174 offset:2048
    v_mfma_f32_16x16x32_bf16 v[136:139], v[212:215], v[12:15], v[136:139]
    s_waitcnt lgkmcnt(8)
    v_mfma_f32_16x16x32_bf16 v[80:83], v[216:219], v[8:11], v[80:83]
    ds_read_b64_tr_b16 v[204:205], v160 offset:16384
    ds_read_b64_tr_b16 v[206:207], v160 offset:18432
    v_mfma_f32_16x16x32_bf16 v[140:143], v[216:219], v[12:15], v[140:143]
    s_waitcnt lgkmcnt(8)
    v_mfma_f32_16x16x32_bf16 v[84:87], v[220:223], v[8:11], v[84:87]
    ds_read_b64_tr_b16 v[208:209], v161 offset:16384
    ds_read_b64_tr_b16 v[210:211], v161 offset:18432
    v_mfma_f32_16x16x32_bf16 v[144:147], v[220:223], v[12:15], v[144:147]
    s_waitcnt lgkmcnt(8)
    v_mfma_f32_16x16x32_bf16 v[88:91], v[192:195], v[8:11], v[88:91]
    ds_read_b64_tr_b16 v[212:213], v162 offset:16384
    ds_read_b64_tr_b16 v[214:215], v162 offset:18432
    v_mfma_f32_16x16x32_bf16 v[148:151], v[192:195], v[12:15], v[148:151]
    s_waitcnt lgkmcnt(8)
    v_mfma_f32_16x16x32_bf16 v[92:95], v[196:199], v[8:11], v[92:95]
    ds_read_b64_tr_b16 v[216:217], v163 offset:16384
    ds_read_b64_tr_b16 v[218:219], v163 offset:18432
    v_mfma_f32_16x16x32_bf16 v[152:155], v[196:199], v[12:15], v[152:155]
    s_waitcnt lgkmcnt(8)
    v_mfma_f32_16x16x32_bf16 v[96:99], v[200:203], v[8:11], v[96:99]
    ds_read_b64_tr_b16 v[220:221], v164 offset:16384
    ds_read_b64_tr_b16 v[222:223], v164 offset:18432
    v_mfma_f32_16x16x32_bf16 v[156:159], v[200:203], v[12:15], v[156:159]
    s_waitcnt lgkmcnt(8)
    v_mfma_f32_16x16x32_bf16 v[40:43], v[204:207], v[16:19], v[40:43]
    ds_read_b64_tr_b16 v[192:193], v165 offset:16384
    ds_read_b64_tr_b16 v[194:195], v165 offset:18432
    v_mfma_f32_16x16x32_bf16 v[100:103], v[204:207], v[20:23], v[100:103]
    s_waitcnt lgkmcnt(8)
    v_mfma_f32_16x16x32_bf16 v[44:47], v[208:211], v[16:19], v[44:47]
    ds_read_b64_tr_b16 v[196:197], v166 offset:16384
    ds_read_b64_tr_b16 v[198:199], v166 offset:18432
    v_mfma_f32_16x16x32_bf16 v[104:107], v[208:211], v[20:23], v[104:107]
    s_waitcnt lgkmcnt(8)
    v_mfma_f32_16x16x32_bf16 v[48:51], v[212:215], v[16:19], v[48:51]
    ds_read_b64_tr_b16 v[200:201], v167 offset:16384
    ds_read_b64_tr_b16 v[202:203], v167 offset:18432
    v_mfma_f32_16x16x32_bf16 v[108:111], v[212:215], v[20:23], v[108:111]
    s_waitcnt lgkmcnt(8)
    v_mfma_f32_16x16x32_bf16 v[52:55], v[216:219], v[16:19], v[52:55]
    ds_read_b64_tr_b16 v[204:205], v168 offset:16384
    ds_read_b64_tr_b16 v[206:207], v168 offset:18432
    v_mfma_f32_16x16x32_bf16 v[112:115], v[216:219], v[20:23], v[112:115]
    s_waitcnt lgkmcnt(8)
    v_mfma_f32_16x16x32_bf16 v[56:59], v[220:223], v[16:19], v[56:59]
    ds_read_b64_tr_b16 v[208:209], v169 offset:16384
    ds_read_b64_tr_b16 v[210:211], v169 offset:18432
    v_mfma_f32_16x16x32_bf16 v[116:119], v[220:223], v[20:23], v[116:119]
    s_waitcnt lgkmcnt(8)
    v_mfma_f32_16x16x32_bf16 v[60:63], v[192:195], v[16:19], v[60:63]
    ds_read_b64_tr_b16 v[212:213], v170 offset:16384
    ds_read_b64_tr_b16 v[214:215], v170 offset:18432
    v_mfma_f32_16x16x32_bf16 v[120:123], v[192:195], v[20:23], v[120:123]
    s_waitcnt lgkmcnt(8)
    v_mfma_f32_16x16x32_bf16 v[64:67], v[196:199], v[16:19], v[64:67]
    ds_read_b64_tr_b16 v[216:217], v171 offset:16384
    ds_read_b64_tr_b16 v[218:219], v171 offset:18432
    v_mfma_f32_16x16x32_bf16 v[124:127], v[196:199], v[20:23], v[124:127]
    ds_read_b64_tr_b16 v[220:221], v172 offset:16384
    ds_read_b64_tr_b16 v[222:223], v172 offset:18432
    s_waitcnt lgkmcnt(10)
    v_mfma_f32_16x16x32_bf16 v[68:71], v[200:203], v[16:19], v[68:71]
    ds_read_b64_tr_b16 v[192:193], v173 offset:16384
    ds_read_b64_tr_b16 v[194:195], v173 offset:18432
    v_mfma_f32_16x16x32_bf16 v[128:131], v[200:203], v[20:23], v[128:131]
    ds_read_b64_tr_b16 v[196:197], v174 offset:16384
    ds_read_b64_tr_b16 v[198:199], v174 offset:18432
    s_waitcnt lgkmcnt(12)
    v_mfma_f32_16x16x32_bf16 v[72:75], v[204:207], v[16:19], v[72:75]
    v_mfma_f32_16x16x32_bf16 v[132:135], v[204:207], v[20:23], v[132:135]
    s_waitcnt lgkmcnt(10)
    v_mfma_f32_16x16x32_bf16 v[76:79], v[208:211], v[16:19], v[76:79]
    v_mfma_f32_16x16x32_bf16 v[136:139], v[208:211], v[20:23], v[136:139]
    s_waitcnt lgkmcnt(0)
    s_barrier
    v_mfma_f32_16x16x32_bf16 v[80:83], v[212:215], v[16:19], v[80:83]
    ds_read_b64_tr_b16 v[200:201], v160 offset:32768
    ds_read_b64_tr_b16 v[202:203], v160 offset:34816
    v_mfma_f32_16x16x32_bf16 v[140:143], v[212:215], v[20:23], v[140:143]
    v_mfma_f32_16x16x32_bf16 v[84:87], v[216:219], v[16:19], v[84:87]
    ds_read_b64_tr_b16 v[204:205], v161 offset:32768
    ds_read_b64_tr_b16 v[206:207], v161 offset:34816
    v_mfma_f32_16x16x32_bf16 v[144:147], v[216:219], v[20:23], v[144:147]
    ds_read_b128 v[8:11], v4 offset:16384
    ds_read_b128 v[12:15], v4 offset:18432
    v_mfma_f32_16x16x32_bf16 v[88:91], v[220:223], v[16:19], v[88:91]
    ds_read_b64_tr_b16 v[208:209], v162 offset:32768
    ds_read_b64_tr_b16 v[210:211], v162 offset:34816
    v_mfma_f32_16x16x32_bf16 v[148:151], v[220:223], v[20:23], v[148:151]
    v_mfma_f32_16x16x32_bf16 v[92:95], v[192:195], v[16:19], v[92:95]
    ds_read_b64_tr_b16 v[212:213], v163 offset:32768
    ds_read_b64_tr_b16 v[214:215], v163 offset:34816
    v_mfma_f32_16x16x32_bf16 v[152:155], v[192:195], v[20:23], v[152:155]
    v_mfma_f32_16x16x32_bf16 v[96:99], v[196:199], v[16:19], v[96:99]
    ds_read_b64_tr_b16 v[216:217], v164 offset:32768
    ds_read_b64_tr_b16 v[218:219], v164 offset:34816
    v_mfma_f32_16x16x32_bf16 v[156:159], v[196:199], v[20:23], v[156:159]
    s_waitcnt lgkmcnt(6)
    v_mfma_f32_16x16x32_bf16 v[40:43], v[200:203], v[8:11], v[40:43]
    ds_read_b64_tr_b16 v[220:221], v165 offset:32768
    ds_read_b64_tr_b16 v[222:223], v165 offset:34816
    v_mfma_f32_16x16x32_bf16 v[100:103], v[200:203], v[12:15], v[100:103]
    s_waitcnt lgkmcnt(8)
    v_mfma_f32_16x16x32_bf16 v[44:47], v[204:207], v[8:11], v[44:47]
    ds_read_b64_tr_b16 v[192:193], v166 offset:32768
    ds_read_b64_tr_b16 v[194:195], v166 offset:34816
    v_mfma_f32_16x16x32_bf16 v[104:107], v[204:207], v[12:15], v[104:107]
    s_waitcnt lgkmcnt(8)
    v_mfma_f32_16x16x32_bf16 v[48:51], v[208:211], v[8:11], v[48:51]
    ds_read_b64_tr_b16 v[196:197], v167 offset:32768
    ds_read_b64_tr_b16 v[198:199], v167 offset:34816
    v_mfma_f32_16x16x32_bf16 v[108:111], v[208:211], v[12:15], v[108:111]
    ds_read_b128 v[16:19], v5 offset:16384
    ds_read_b128 v[20:23], v5 offset:18432
    s_waitcnt lgkmcnt(10)
    v_mfma_f32_16x16x32_bf16 v[52:55], v[212:215], v[8:11], v[52:55]
    ds_read_b64_tr_b16 v[200:201], v168 offset:32768
    ds_read_b64_tr_b16 v[202:203], v168 offset:34816
    v_mfma_f32_16x16x32_bf16 v[112:115], v[212:215], v[12:15], v[112:115]
    s_waitcnt lgkmcnt(10)
    v_mfma_f32_16x16x32_bf16 v[56:59], v[216:219], v[8:11], v[56:59]
    ds_read_b64_tr_b16 v[204:205], v169 offset:32768
    ds_read_b64_tr_b16 v[206:207], v169 offset:34816
    v_mfma_f32_16x16x32_bf16 v[116:119], v[216:219], v[12:15], v[116:119]
    s_waitcnt lgkmcnt(10)
    v_mfma_f32_16x16x32_bf16 v[60:63], v[220:223], v[8:11], v[60:63]
    ds_read_b64_tr_b16 v[208:209], v170 offset:32768
    ds_read_b64_tr_b16 v[210:211], v170 offset:34816
    v_mfma_f32_16x16x32_bf16 v[120:123], v[220:223], v[12:15], v[120:123]
    s_waitcnt lgkmcnt(10)
    v_mfma_f32_16x16x32_bf16 v[64:67], v[192:195], v[8:11], v[64:67]
    ds_read_b64_tr_b16 v[212:213], v171 offset:32768
    ds_read_b64_tr_b16 v[214:215], v171 offset:34816
    v_mfma_f32_16x16x32_bf16 v[124:127], v[192:195], v[12:15], v[124:127]
    s_waitcnt lgkmcnt(10)
    v_mfma_f32_16x16x32_bf16 v[68:71], v[196:199], v[8:11], v[68:71]
    ds_read_b64_tr_b16 v[216:217], v172 offset:32768
    ds_read_b64_tr_b16 v[218:219], v172 offset:34816
    v_mfma_f32_16x16x32_bf16 v[128:131], v[196:199], v[12:15], v[128:131]
    s_waitcnt lgkmcnt(8)
    v_mfma_f32_16x16x32_bf16 v[72:75], v[200:203], v[8:11], v[72:75]
    ds_read_b64_tr_b16 v[220:221], v173 offset:32768
    ds_read_b64_tr_b16 v[222:223], v173 offset:34816
    v_mfma_f32_16x16x32_bf16 v[132:135], v[200:203], v[12:15], v[132:135]
    s_waitcnt lgkmcnt(8)
    v_mfma_f32_16x16x32_bf16 v[76:79], v[204:207], v[8:11], v[76:79]
    ds_read_b64_tr_b16 v[192:193], v174 offset:32768
    ds_read_b64_tr_b16 v[194:195], v174 offset:34816
    v_mfma_f32_16x16x32_bf16 v[136:139], v[204:207], v[12:15], v[136:139]
    s_waitcnt lgkmcnt(8)
    v_mfma_f32_16x16x32_bf16 v[80:83], v[208:211], v[8:11], v[80:83]
    ds_read_b64_tr_b16 v[196:197], v160 offset:49152
    ds_read_b64_tr_b16 v[198:199], v160 offset:51200
    v_mfma_f32_16x16x32_bf16 v[140:143], v[208:211], v[12:15], v[140:143]
    s_waitcnt lgkmcnt(8)
    v_mfma_f32_16x16x32_bf16 v[84:87], v[212:215], v[8:11], v[84:87]
    ds_read_b64_tr_b16 v[200:201], v161 offset:49152
    ds_read_b64_tr_b16 v[202:203], v161 offset:51200
    v_mfma_f32_16x16x32_bf16 v[144:147], v[212:215], v[12:15], v[144:147]
    s_waitcnt lgkmcnt(8)
    v_mfma_f32_16x16x32_bf16 v[88:91], v[216:219], v[8:11], v[88:91]
    ds_read_b64_tr_b16 v[204:205], v162 offset:49152
    ds_read_b64_tr_b16 v[206:207], v162 offset:51200
    v_mfma_f32_16x16x32_bf16 v[148:151], v[216:219], v[12:15], v[148:151]
    s_waitcnt lgkmcnt(8)
    v_mfma_f32_16x16x32_bf16 v[92:95], v[220:223], v[8:11], v[92:95]
    ds_read_b64_tr_b16 v[208:209], v163 offset:49152
    ds_read_b64_tr_b16 v[210:211], v163 offset:51200
    v_mfma_f32_16x16x32_bf16 v[152:155], v[220:223], v[12:15], v[152:155]
    s_waitcnt lgkmcnt(8)
    v_mfma_f32_16x16x32_bf16 v[96:99], v[192:195], v[8:11], v[96:99]
    ds_read_b64_tr_b16 v[212:213], v164 offset:49152
    ds_read_b64_tr_b16 v[214:215], v164 offset:51200
    v_mfma_f32_16x16x32_bf16 v[156:159], v[192:195], v[12:15], v[156:159]
    s_waitcnt lgkmcnt(8)
    v_mfma_f32_16x16x32_bf16 v[40:43], v[196:199], v[16:19], v[40:43]
    ds_read_b64_tr_b16 v[216:217], v165 offset:49152
    ds_read_b64_tr_b16 v[218:219], v165 offset:51200
    v_mfma_f32_16x16x32_bf16 v[100:103], v[196:199], v[20:23], v[100:103]
    s_waitcnt lgkmcnt(8)
    v_mfma_f32_16x16x32_bf16 v[44:47], v[200:203], v[16:19], v[44:47]
    ds_read_b64_tr_b16 v[220:221], v166 offset:49152
    ds_read_b64_tr_b16 v[222:223], v166 offset:51200
    v_mfma_f32_16x16x32_bf16 v[104:107], v[200:203], v[20:23], v[104:107]
    s_waitcnt lgkmcnt(8)
    v_mfma_f32_16x16x32_bf16 v[48:51], v[204:207], v[16:19], v[48:51]
    ds_read_b64_tr_b16 v[192:193], v167 offset:49152
    ds_read_b64_tr_b16 v[194:195], v167 offset:51200
    v_mfma_f32_16x16x32_bf16 v[108:111], v[204:207], v[20:23], v[108:111]
    s_waitcnt lgkmcnt(8)
    v_mfma_f32_16x16x32_bf16 v[52:55], v[208:211], v[16:19], v[52:55]
    ds_read_b64_tr_b16 v[196:197], v168 offset:49152
    ds_read_b64_tr_b16 v[198:199], v168 offset:51200
    v_mfma_f32_16x16x32_bf16 v[112:115], v[208:211], v[20:23], v[112:115]
    s_waitcnt lgkmcnt(8)
    v_mfma_f32_16x16x32_bf16 v[56:59], v[212:215], v[16:19], v[56:59]
    ds_read_b64_tr_b16 v[200:201], v169 offset:49152
    ds_read_b64_tr_b16 v[202:203], v169 offset:51200
    v_mfma_f32_16x16x32_bf16 v[116:119], v[212:215], v[20:23], v[116:119]
    s_waitcnt lgkmcnt(8)
    v_mfma_f32_16x16x32_bf16 v[60:63], v[216:219], v[16:19], v[60:63]
    ds_read_b64_tr_b16 v[204:205], v170 offset:49152
    ds_read_b64_tr_b16 v[206:207], v170 offset:51200
    v_mfma_f32_16x16x32_bf16 v[120:123], v[216:219], v[20:23], v[120:123]
    s_waitcnt lgkmcnt(8)
    v_mfma_f32_16x16x32_bf16 v[64:67], v[220:223], v[16:19], v[64:67]
    ds_read_b64_tr_b16 v[208:209], v171 offset:49152
    ds_read_b64_tr_b16 v[210:211], v171 offset:51200
    v_mfma_f32_16x16x32_bf16 v[124:127], v[220:223], v[20:23], v[124:127]
    ds_read_b64_tr_b16 v[212:213], v172 offset:49152
    ds_read_b64_tr_b16 v[214:215], v172 offset:51200
    s_waitcnt lgkmcnt(10)
    v_mfma_f32_16x16x32_bf16 v[68:71], v[192:195], v[16:19], v[68:71]
    ds_read_b64_tr_b16 v[216:217], v173 offset:49152
    ds_read_b64_tr_b16 v[218:219], v173 offset:51200
    v_mfma_f32_16x16x32_bf16 v[128:131], v[192:195], v[20:23], v[128:131]
    ds_read_b64_tr_b16 v[220:221], v174 offset:49152
    ds_read_b64_tr_b16 v[222:223], v174 offset:51200
    s_waitcnt lgkmcnt(12)
    v_mfma_f32_16x16x32_bf16 v[72:75], v[196:199], v[16:19], v[72:75]
    v_mfma_f32_16x16x32_bf16 v[132:135], v[196:199], v[20:23], v[132:135]
    s_waitcnt lgkmcnt(10)
    v_mfma_f32_16x16x32_bf16 v[76:79], v[200:203], v[16:19], v[76:79]
    v_mfma_f32_16x16x32_bf16 v[136:139], v[200:203], v[20:23], v[136:139]
    s_waitcnt lgkmcnt(0)
    s_barrier
    v_mfma_f32_16x16x32_bf16 v[80:83], v[204:207], v[16:19], v[80:83]
    ds_read_b64_tr_b16 v[192:193], v175 offset:0
    ds_read_b64_tr_b16 v[194:195], v175 offset:2048
    v_mfma_f32_16x16x32_bf16 v[140:143], v[204:207], v[20:23], v[140:143]
    v_mfma_f32_16x16x32_bf16 v[84:87], v[208:211], v[16:19], v[84:87]
    ds_read_b64_tr_b16 v[196:197], v176 offset:0
    ds_read_b64_tr_b16 v[198:199], v176 offset:2048
    v_mfma_f32_16x16x32_bf16 v[144:147], v[208:211], v[20:23], v[144:147]
    ds_read_b128 v[8:11], v4 offset:32768
    ds_read_b128 v[12:15], v4 offset:34816
    v_mfma_f32_16x16x32_bf16 v[88:91], v[212:215], v[16:19], v[88:91]
    ds_read_b64_tr_b16 v[200:201], v177 offset:0
    ds_read_b64_tr_b16 v[202:203], v177 offset:2048
    v_mfma_f32_16x16x32_bf16 v[148:151], v[212:215], v[20:23], v[148:151]
    v_mfma_f32_16x16x32_bf16 v[92:95], v[216:219], v[16:19], v[92:95]
    ds_read_b64_tr_b16 v[204:205], v178 offset:0
    ds_read_b64_tr_b16 v[206:207], v178 offset:2048
    v_mfma_f32_16x16x32_bf16 v[152:155], v[216:219], v[20:23], v[152:155]
    v_mfma_f32_16x16x32_bf16 v[96:99], v[220:223], v[16:19], v[96:99]
    ds_read_b64_tr_b16 v[208:209], v179 offset:0
    ds_read_b64_tr_b16 v[210:211], v179 offset:2048
    v_mfma_f32_16x16x32_bf16 v[156:159], v[220:223], v[20:23], v[156:159]
    s_waitcnt lgkmcnt(6)
    v_mfma_f32_16x16x32_bf16 v[40:43], v[192:195], v[8:11], v[40:43]
    ds_read_b64_tr_b16 v[212:213], v180 offset:0
    ds_read_b64_tr_b16 v[214:215], v180 offset:2048
    v_mfma_f32_16x16x32_bf16 v[100:103], v[192:195], v[12:15], v[100:103]
    s_waitcnt lgkmcnt(8)
    v_mfma_f32_16x16x32_bf16 v[44:47], v[196:199], v[8:11], v[44:47]
    ds_read_b64_tr_b16 v[216:217], v181 offset:0
    ds_read_b64_tr_b16 v[218:219], v181 offset:2048
    v_mfma_f32_16x16x32_bf16 v[104:107], v[196:199], v[12:15], v[104:107]
    s_waitcnt lgkmcnt(8)
    v_mfma_f32_16x16x32_bf16 v[48:51], v[200:203], v[8:11], v[48:51]
    ds_read_b64_tr_b16 v[220:221], v182 offset:0
    ds_read_b64_tr_b16 v[222:223], v182 offset:2048
    v_mfma_f32_16x16x32_bf16 v[108:111], v[200:203], v[12:15], v[108:111]
    ds_read_b128 v[16:19], v5 offset:32768
    ds_read_b128 v[20:23], v5 offset:34816
    s_waitcnt lgkmcnt(10)
    v_mfma_f32_16x16x32_bf16 v[52:55], v[204:207], v[8:11], v[52:55]
    ds_read_b64_tr_b16 v[192:193], v183 offset:0
    ds_read_b64_tr_b16 v[194:195], v183 offset:2048
    v_mfma_f32_16x16x32_bf16 v[112:115], v[204:207], v[12:15], v[112:115]
    s_waitcnt lgkmcnt(10)
    v_mfma_f32_16x16x32_bf16 v[56:59], v[208:211], v[8:11], v[56:59]
    ds_read_b64_tr_b16 v[196:197], v184 offset:0
    ds_read_b64_tr_b16 v[198:199], v184 offset:2048
    v_mfma_f32_16x16x32_bf16 v[116:119], v[208:211], v[12:15], v[116:119]
    s_waitcnt lgkmcnt(10)
    v_mfma_f32_16x16x32_bf16 v[60:63], v[212:215], v[8:11], v[60:63]
    ds_read_b64_tr_b16 v[200:201], v185 offset:0
    ds_read_b64_tr_b16 v[202:203], v185 offset:2048
    v_mfma_f32_16x16x32_bf16 v[120:123], v[212:215], v[12:15], v[120:123]
    s_waitcnt lgkmcnt(10)
    v_mfma_f32_16x16x32_bf16 v[64:67], v[216:219], v[8:11], v[64:67]
    ds_read_b64_tr_b16 v[204:205], v186 offset:0
    ds_read_b64_tr_b16 v[206:207], v186 offset:2048
    v_mfma_f32_16x16x32_bf16 v[124:127], v[216:219], v[12:15], v[124:127]
    s_waitcnt lgkmcnt(10)
    v_mfma_f32_16x16x32_bf16 v[68:71], v[220:223], v[8:11], v[68:71]
    ds_read_b64_tr_b16 v[208:209], v187 offset:0
    ds_read_b64_tr_b16 v[210:211], v187 offset:2048
    v_mfma_f32_16x16x32_bf16 v[128:131], v[220:223], v[12:15], v[128:131]
    s_waitcnt lgkmcnt(8)
    v_mfma_f32_16x16x32_bf16 v[72:75], v[192:195], v[8:11], v[72:75]
    ds_read_b64_tr_b16 v[212:213], v188 offset:0
    ds_read_b64_tr_b16 v[214:215], v188 offset:2048
    v_mfma_f32_16x16x32_bf16 v[132:135], v[192:195], v[12:15], v[132:135]
    s_waitcnt lgkmcnt(8)
    v_mfma_f32_16x16x32_bf16 v[76:79], v[196:199], v[8:11], v[76:79]
    ds_read_b64_tr_b16 v[216:217], v189 offset:0
    ds_read_b64_tr_b16 v[218:219], v189 offset:2048
    v_mfma_f32_16x16x32_bf16 v[136:139], v[196:199], v[12:15], v[136:139]
    s_waitcnt lgkmcnt(8)
    v_mfma_f32_16x16x32_bf16 v[80:83], v[200:203], v[8:11], v[80:83]
    ds_read_b64_tr_b16 v[220:221], v175 offset:16384
    ds_read_b64_tr_b16 v[222:223], v175 offset:18432
    v_mfma_f32_16x16x32_bf16 v[140:143], v[200:203], v[12:15], v[140:143]
    s_waitcnt lgkmcnt(8)
    v_mfma_f32_16x16x32_bf16 v[84:87], v[204:207], v[8:11], v[84:87]
    ds_read_b64_tr_b16 v[192:193], v176 offset:16384
    ds_read_b64_tr_b16 v[194:195], v176 offset:18432
    v_mfma_f32_16x16x32_bf16 v[144:147], v[204:207], v[12:15], v[144:147]
    s_waitcnt lgkmcnt(8)
    v_mfma_f32_16x16x32_bf16 v[88:91], v[208:211], v[8:11], v[88:91]
    ds_read_b64_tr_b16 v[196:197], v177 offset:16384
    ds_read_b64_tr_b16 v[198:199], v177 offset:18432
    v_mfma_f32_16x16x32_bf16 v[148:151], v[208:211], v[12:15], v[148:151]
    s_waitcnt lgkmcnt(8)
    v_mfma_f32_16x16x32_bf16 v[92:95], v[212:215], v[8:11], v[92:95]
    ds_read_b64_tr_b16 v[200:201], v178 offset:16384
    ds_read_b64_tr_b16 v[202:203], v178 offset:18432
    v_mfma_f32_16x16x32_bf16 v[152:155], v[212:215], v[12:15], v[152:155]
    s_waitcnt lgkmcnt(8)
    v_mfma_f32_16x16x32_bf16 v[96:99], v[216:219], v[8:11], v[96:99]
    ds_read_b64_tr_b16 v[204:205], v179 offset:16384
    ds_read_b64_tr_b16 v[206:207], v179 offset:18432
    v_mfma_f32_16x16x32_bf16 v[156:159], v[216:219], v[12:15], v[156:159]
    s_waitcnt lgkmcnt(8)
    v_mfma_f32_16x16x32_bf16 v[40:43], v[220:223], v[16:19], v[40:43]
    ds_read_b64_tr_b16 v[208:209], v180 offset:16384
    ds_read_b64_tr_b16 v[210:211], v180 offset:18432
    v_mfma_f32_16x16x32_bf16 v[100:103], v[220:223], v[20:23], v[100:103]
    s_waitcnt lgkmcnt(8)
    v_mfma_f32_16x16x32_bf16 v[44:47], v[192:195], v[16:19], v[44:47]
    ds_read_b64_tr_b16 v[212:213], v181 offset:16384
    ds_read_b64_tr_b16 v[214:215], v181 offset:18432
    v_mfma_f32_16x16x32_bf16 v[104:107], v[192:195], v[20:23], v[104:107]
    s_waitcnt lgkmcnt(8)
    v_mfma_f32_16x16x32_bf16 v[48:51], v[196:199], v[16:19], v[48:51]
    ds_read_b64_tr_b16 v[216:217], v182 offset:16384
    ds_read_b64_tr_b16 v[218:219], v182 offset:18432
    v_mfma_f32_16x16x32_bf16 v[108:111], v[196:199], v[20:23], v[108:111]
    s_waitcnt lgkmcnt(8)
    v_mfma_f32_16x16x32_bf16 v[52:55], v[200:203], v[16:19], v[52:55]
    ds_read_b64_tr_b16 v[220:221], v183 offset:16384
    ds_read_b64_tr_b16 v[222:223], v183 offset:18432
    v_mfma_f32_16x16x32_bf16 v[112:115], v[200:203], v[20:23], v[112:115]
    s_waitcnt lgkmcnt(8)
    v_mfma_f32_16x16x32_bf16 v[56:59], v[204:207], v[16:19], v[56:59]
    ds_read_b64_tr_b16 v[192:193], v184 offset:16384
    ds_read_b64_tr_b16 v[194:195], v184 offset:18432
    v_mfma_f32_16x16x32_bf16 v[116:119], v[204:207], v[20:23], v[116:119]
    s_waitcnt lgkmcnt(8)
    v_mfma_f32_16x16x32_bf16 v[60:63], v[208:211], v[16:19], v[60:63]
    ds_read_b64_tr_b16 v[196:197], v185 offset:16384
    ds_read_b64_tr_b16 v[198:199], v185 offset:18432
    v_mfma_f32_16x16x32_bf16 v[120:123], v[208:211], v[20:23], v[120:123]
    s_waitcnt lgkmcnt(8)
    v_mfma_f32_16x16x32_bf16 v[64:67], v[212:215], v[16:19], v[64:67]
    ds_read_b64_tr_b16 v[200:201], v186 offset:16384
    ds_read_b64_tr_b16 v[202:203], v186 offset:18432
    v_mfma_f32_16x16x32_bf16 v[124:127], v[212:215], v[20:23], v[124:127]
    ds_read_b64_tr_b16 v[204:205], v187 offset:16384
    ds_read_b64_tr_b16 v[206:207], v187 offset:18432
    s_waitcnt lgkmcnt(10)
    v_mfma_f32_16x16x32_bf16 v[68:71], v[216:219], v[16:19], v[68:71]
    ds_read_b64_tr_b16 v[208:209], v188 offset:16384
    ds_read_b64_tr_b16 v[210:211], v188 offset:18432
    v_mfma_f32_16x16x32_bf16 v[128:131], v[216:219], v[20:23], v[128:131]
    ds_read_b64_tr_b16 v[212:213], v189 offset:16384
    ds_read_b64_tr_b16 v[214:215], v189 offset:18432
    s_waitcnt lgkmcnt(12)
    v_mfma_f32_16x16x32_bf16 v[72:75], v[220:223], v[16:19], v[72:75]
    v_mfma_f32_16x16x32_bf16 v[132:135], v[220:223], v[20:23], v[132:135]
    s_waitcnt lgkmcnt(10)
    v_mfma_f32_16x16x32_bf16 v[76:79], v[192:195], v[16:19], v[76:79]
    v_mfma_f32_16x16x32_bf16 v[136:139], v[192:195], v[20:23], v[136:139]
    s_waitcnt lgkmcnt(0)
    s_barrier
    v_mfma_f32_16x16x32_bf16 v[80:83], v[196:199], v[16:19], v[80:83]
    ds_read_b64_tr_b16 v[216:217], v160 offset:0
    ds_read_b64_tr_b16 v[218:219], v160 offset:2048
    v_mfma_f32_16x16x32_bf16 v[140:143], v[196:199], v[20:23], v[140:143]
    v_mfma_f32_16x16x32_bf16 v[84:87], v[200:203], v[16:19], v[84:87]
    ds_read_b64_tr_b16 v[220:221], v161 offset:0
    ds_read_b64_tr_b16 v[222:223], v161 offset:2048
    v_mfma_f32_16x16x32_bf16 v[144:147], v[200:203], v[20:23], v[144:147]
    ds_read_b128 v[8:11], v4 offset:0
    ds_read_b128 v[12:15], v4 offset:2048
    v_mfma_f32_16x16x32_bf16 v[88:91], v[204:207], v[16:19], v[88:91]
    ds_read_b64_tr_b16 v[192:193], v162 offset:0
    ds_read_b64_tr_b16 v[194:195], v162 offset:2048
    v_mfma_f32_16x16x32_bf16 v[148:151], v[204:207], v[20:23], v[148:151]
    v_mfma_f32_16x16x32_bf16 v[92:95], v[208:211], v[16:19], v[92:95]
    ds_read_b64_tr_b16 v[196:197], v163 offset:0
    ds_read_b64_tr_b16 v[198:199], v163 offset:2048
    v_mfma_f32_16x16x32_bf16 v[152:155], v[208:211], v[20:23], v[152:155]
    v_mfma_f32_16x16x32_bf16 v[96:99], v[212:215], v[16:19], v[96:99]
    ds_read_b64_tr_b16 v[200:201], v164 offset:0
    ds_read_b64_tr_b16 v[202:203], v164 offset:2048
    v_mfma_f32_16x16x32_bf16 v[156:159], v[212:215], v[20:23], v[156:159]
    s_waitcnt lgkmcnt(6)
    v_mfma_f32_16x16x32_bf16 v[40:43], v[216:219], v[8:11], v[40:43]
    ds_read_b64_tr_b16 v[204:205], v160 offset:16384
    ds_read_b64_tr_b16 v[206:207], v160 offset:18432
    v_mfma_f32_16x16x32_bf16 v[100:103], v[216:219], v[12:15], v[100:103]
    ds_read_b128 v[16:19], v5 offset:0
    ds_read_b128 v[20:23], v5 offset:2048
    s_waitcnt lgkmcnt(10)
    v_mfma_f32_16x16x32_bf16 v[44:47], v[220:223], v[8:11], v[44:47]
    ds_read_b64_tr_b16 v[208:209], v161 offset:16384
    ds_read_b64_tr_b16 v[210:211], v161 offset:18432
    v_mfma_f32_16x16x32_bf16 v[104:107], v[220:223], v[12:15], v[104:107]
    s_waitcnt lgkmcnt(10)
    v_mfma_f32_16x16x32_bf16 v[48:51], v[192:195], v[8:11], v[48:51]
    ds_read_b64_tr_b16 v[212:213], v162 offset:16384
    ds_read_b64_tr_b16 v[214:215], v162 offset:18432
    v_mfma_f32_16x16x32_bf16 v[108:111], v[192:195], v[12:15], v[108:111]
    s_waitcnt lgkmcnt(10)
    v_mfma_f32_16x16x32_bf16 v[52:55], v[196:199], v[8:11], v[52:55]
    ds_read_b64_tr_b16 v[216:217], v163 offset:16384
    ds_read_b64_tr_b16 v[218:219], v163 offset:18432
    v_mfma_f32_16x16x32_bf16 v[112:115], v[196:199], v[12:15], v[112:115]
    s_waitcnt lgkmcnt(10)
    v_mfma_f32_16x16x32_bf16 v[56:59], v[200:203], v[8:11], v[56:59]
    ds_read_b64_tr_b16 v[220:221], v164 offset:16384
    ds_read_b64_tr_b16 v[222:223], v164 offset:18432
    v_mfma_f32_16x16x32_bf16 v[116:119], v[200:203], v[12:15], v[116:119]
    s_waitcnt lgkmcnt(8)
    v_mfma_f32_16x16x32_bf16 v[40:43], v[204:207], v[16:19], v[40:43]
    ds_read_b64_tr_b16 v[192:193], v165 offset:0
    ds_read_b64_tr_b16 v[194:195], v165 offset:2048
    v_mfma_f32_16x16x32_bf16 v[100:103], v[204:207], v[20:23], v[100:103]
    s_waitcnt lgkmcnt(8)
    v_mfma_f32_16x16x32_bf16 v[44:47], v[208:211], v[16:19], v[44:47]
    ds_read_b64_tr_b16 v[196:197], v166 offset:0
    ds_read_b64_tr_b16 v[198:199], v166 offset:2048
    v_mfma_f32_16x16x32_bf16 v[104:107], v[208:211], v[20:23], v[104:107]
    s_waitcnt lgkmcnt(8)
    v_mfma_f32_16x16x32_bf16 v[48:51], v[212:215], v[16:19], v[48:51]
    ds_read_b64_tr_b16 v[200:201], v167 offset:0
    ds_read_b64_tr_b16 v[202:203], v167 offset:2048
    v_mfma_f32_16x16x32_bf16 v[108:111], v[212:215], v[20:23], v[108:111]
    s_waitcnt lgkmcnt(8)
    v_mfma_f32_16x16x32_bf16 v[52:55], v[216:219], v[16:19], v[52:55]
    ds_read_b64_tr_b16 v[204:205], v168 offset:0
    ds_read_b64_tr_b16 v[206:207], v168 offset:2048
    v_mfma_f32_16x16x32_bf16 v[112:115], v[216:219], v[20:23], v[112:115]
    s_waitcnt lgkmcnt(8)
    v_mfma_f32_16x16x32_bf16 v[56:59], v[220:223], v[16:19], v[56:59]
    ds_read_b64_tr_b16 v[208:209], v169 offset:0
    ds_read_b64_tr_b16 v[210:211], v169 offset:2048
    v_mfma_f32_16x16x32_bf16 v[116:119], v[220:223], v[20:23], v[116:119]
    s_waitcnt lgkmcnt(8)
    v_mfma_f32_16x16x32_bf16 v[60:63], v[192:195], v[8:11], v[60:63]
    ds_read_b64_tr_b16 v[212:213], v165 offset:16384
    ds_read_b64_tr_b16 v[214:215], v165 offset:18432
    v_mfma_f32_16x16x32_bf16 v[120:123], v[192:195], v[12:15], v[120:123]
    s_waitcnt lgkmcnt(8)
    v_mfma_f32_16x16x32_bf16 v[64:67], v[196:199], v[8:11], v[64:67]
    ds_read_b64_tr_b16 v[216:217], v166 offset:16384
    ds_read_b64_tr_b16 v[218:219], v166 offset:18432
    v_mfma_f32_16x16x32_bf16 v[124:127], v[196:199], v[12:15], v[124:127]
    s_waitcnt lgkmcnt(8)
    v_mfma_f32_16x16x32_bf16 v[68:71], v[200:203], v[8:11], v[68:71]
    ds_read_b64_tr_b16 v[220:221], v167 offset:16384
    ds_read_b64_tr_b16 v[222:223], v167 offset:18432
    v_mfma_f32_16x16x32_bf16 v[128:131], v[200:203], v[12:15], v[128:131]
    s_cmp_eq_u32 s33, 0
    s_cbranch_scc1 L1_ns0
    v_pk_mul_f32 v[40:41], v[40:41], v[28:29] op_sel_hi:[1,0]
    v_pk_mul_f32 v[42:43], v[42:43], v[28:29] op_sel_hi:[1,0]
    v_pk_mul_f32 v[44:45], v[44:45], v[28:29] op_sel_hi:[1,0]
    v_pk_mul_f32 v[46:47], v[46:47], v[28:29] op_sel_hi:[1,0]
    v_pk_mul_f32 v[48:49], v[48:49], v[28:29] op_sel_hi:[1,0]
    v_pk_mul_f32 v[50:51], v[50:51], v[28:29] op_sel_hi:[1,0]
    v_pk_mul_f32 v[52:53], v[52:53], v[28:29] op_sel_hi:[1,0]
    v_pk_mul_f32 v[54:55], v[54:55], v[28:29] op_sel_hi:[1,0]
    v_pk_mul_f32 v[56:57], v[56:57], v[28:29] op_sel_hi:[1,0]
    v_pk_mul_f32 v[58:59], v[58:59], v[28:29] op_sel_hi:[1,0]
    v_pk_mul_f32 v[100:101], v[100:101], v[28:29] op_sel_hi:[1,0]
    v_pk_mul_f32 v[102:103], v[102:103], v[28:29] op_sel_hi:[1,0]
    v_pk_mul_f32 v[104:105], v[104:105], v[28:29] op_sel_hi:[1,0]
    v_pk_mul_f32 v[106:107], v[106:107], v[28:29] op_sel_hi:[1,0]
    v_pk_mul_f32 v[108:109], v[108:109], v[28:29] op_sel_hi:[1,0]
    v_pk_mul_f32 v[110:111], v[110:111], v[28:29] op_sel_hi:[1,0]
    v_pk_mul_f32 v[112:113], v[112:113], v[28:29] op_sel_hi:[1,0]
    v_pk_mul_f32 v[114:115], v[114:115], v[28:29] op_sel_hi:[1,0]
    v_pk_mul_f32 v[116:117], v[116:117], v[28:29] op_sel_hi:[1,0]
    v_pk_mul_f32 v[118:119], v[118:119], v[28:29] op_sel_hi:[1,0]
L1_ns0:
    s_waitcnt lgkmcnt(8)
    v_mfma_f32_16x16x32_bf16 v[72:75], v[204:207], v[8:11], v[72:75]
    ds_read_b64_tr_b16 v[192:193], v168 offset:16384
    ds_read_b64_tr_b16 v[194:195], v168 offset:18432
    v_mfma_f32_16x16x32_bf16 v[132:135], v[204:207], v[12:15], v[132:135]
    v_cvt_pk_bf16_f32 v224, v40, v41
    v_cvt_pk_bf16_f32 v225, v42, v43
    v_cvt_pk_bf16_f32 v226, v44, v45
    v_cvt_pk_bf16_f32 v227, v46, v47
    v_cvt_pk_bf16_f32 v228, v48, v49
    v_cvt_pk_bf16_f32 v229, v50, v51
    s_waitcnt lgkmcnt(8)
    v_mfma_f32_16x16x32_bf16 v[76:79], v[208:211], v[8:11], v[76:79]
    ds_read_b64_tr_b16 v[196:197], v169 offset:16384
    ds_read_b64_tr_b16 v[198:199], v169 offset:18432
    v_mfma_f32_16x16x32_bf16 v[136:139], v[208:211], v[12:15], v[136:139]
    v_cvt_pk_bf16_f32 v230, v52, v53
    v_cvt_pk_bf16_f32 v231, v54, v55
    v_cvt_pk_bf16_f32 v232, v56, v57
    v_cvt_pk_bf16_f32 v233, v58, v59
    v_mov_b32 v234, v24
    v_mov_b32 v235, 0
    s_waitcnt lgkmcnt(8)
    v_mfma_f32_16x16x32_bf16 v[60:63], v[212:215], v[16:19], v[60:63]
    ds_read_b64_tr_b16 v[200:201], v170 offset:0
    ds_read_b64_tr_b16 v[202:203], v170 offset:2048
    v_mfma_f32_16x16x32_bf16 v[120:123], v[212:215], v[20:23], v[120:123]
    s_mov_b32 s32, 0
    buffer_store_dwordx4 v[224:227], v34, s[16:19], s32 offen offset:0 sc1
    s_waitcnt lgkmcnt(8)
    v_mfma_f32_16x16x32_bf16 v[64:67], v[216:219], v[16:19], v[64:67]
    ds_read_b64_tr_b16 v[204:205], v171 offset:0
    ds_read_b64_tr_b16 v[206:207], v171 offset:2048
    v_mfma_f32_16x16x32_bf16 v[124:127], v[216:219], v[20:23], v[124:127]
    s_mov_b32 s32, 32768
    buffer_store_dwordx4 v[228:231], v34, s[16:19], s32 offen offset:0 sc1
    s_waitcnt lgkmcnt(8)
    v_mfma_f32_16x16x32_bf16 v[68:71], v[220:223], v[16:19], v[68:71]
    ds_read_b64_tr_b16 v[208:209], v172 offset:0
    ds_read_b64_tr_b16 v[210:211], v172 offset:2048
    v_mfma_f32_16x16x32_bf16 v[128:131], v[220:223], v[20:23], v[128:131]
    s_mov_b32 s32, 65536
    buffer_store_dwordx4 v[232:235], v34, s[16:19], s32 offen offset:0 sc1
    s_waitcnt lgkmcnt(8)
    v_mfma_f32_16x16x32_bf16 v[72:75], v[192:195], v[16:19], v[72:75]
    ds_read_b64_tr_b16 v[212:213], v173 offset:0
    ds_read_b64_tr_b16 v[214:215], v173 offset:2048
    v_mfma_f32_16x16x32_bf16 v[132:135], v[192:195], v[20:23], v[132:135]
    v_cvt_pk_bf16_f32 v236, v100, v101
    v_cvt_pk_bf16_f32 v237, v102, v103
    v_cvt_pk_bf16_f32 v238, v104, v105
    v_cvt_pk_bf16_f32 v239, v106, v107
    v_cvt_pk_bf16_f32 v240, v108, v109
    v_cvt_pk_bf16_f32 v241, v110, v111
    s_waitcnt lgkmcnt(8)
    v_mfma_f32_16x16x32_bf16 v[76:79], v[196:199], v[16:19], v[76:79]
    ds_read_b64_tr_b16 v[216:217], v174 offset:0
    ds_read_b64_tr_b16 v[218:219], v174 offset:2048
    v_mfma_f32_16x16x32_bf16 v[136:139], v[196:199], v[20:23], v[136:139]
    v_cvt_pk_bf16_f32 v242, v112, v113
    v_cvt_pk_bf16_f32 v243, v114, v115
    v_cvt_pk_bf16_f32 v244, v116, v117
    v_cvt_pk_bf16_f32 v245, v118, v119
    v_mov_b32 v246, v24
    v_mov_b32 v247, 0
    s_waitcnt lgkmcnt(8)
    v_mfma_f32_16x16x32_bf16 v[80:83], v[200:203], v[8:11], v[80:83]
    ds_read_b64_tr_b16 v[220:221], v170 offset:16384
    ds_read_b64_tr_b16 v[222:223], v170 offset:18432
    v_mfma_f32_16x16x32_bf16 v[140:143], v[200:203], v[12:15], v[140:143]
    s_mov_b32 s32, 0
    buffer_store_dwordx4 v[236:239], v34, s[16:19], s32 offen offset:256 sc1
    s_waitcnt lgkmcnt(8)
    v_mfma_f32_16x16x32_bf16 v[84:87], v[204:207], v[8:11], v[84:87]
    ds_read_b64_tr_b16 v[192:193], v171 offset:16384
    ds_read_b64_tr_b16 v[194:195], v171 offset:18432
    v_mfma_f32_16x16x32_bf16 v[144:147], v[204:207], v[12:15], v[144:147]
    s_mov_b32 s32, 32768
    buffer_store_dwordx4 v[240:243], v34, s[16:19], s32 offen offset:256 sc1
    s_waitcnt lgkmcnt(8)
    v_mfma_f32_16x16x32_bf16 v[88:91], v[208:211], v[8:11], v[88:91]
    ds_read_b64_tr_b16 v[196:197], v172 offset:16384
    ds_read_b64_tr_b16 v[198:199], v172 offset:18432
    v_mfma_f32_16x16x32_bf16 v[148:151], v[208:211], v[12:15], v[148:151]
    s_mov_b32 s32, 65536
    buffer_store_dwordx4 v[244:247], v34, s[16:19], s32 offen offset:256 sc1
    s_waitcnt lgkmcnt(8)
    v_mfma_f32_16x16x32_bf16 v[92:95], v[212:215], v[8:11], v[92:95]
    ds_read_b64_tr_b16 v[200:201], v173 offset:16384
    ds_read_b64_tr_b16 v[202:203], v173 offset:18432
    v_mfma_f32_16x16x32_bf16 v[152:155], v[212:215], v[12:15], v[152:155]
    s_cmp_eq_u32 s33, 0
    s_cbranch_scc1 L1_ns1
    v_pk_mul_f32 v[60:61], v[60:61], v[30:31] op_sel_hi:[1,0]
    v_pk_mul_f32 v[62:63], v[62:63], v[30:31] op_sel_hi:[1,0]
    v_pk_mul_f32 v[64:65], v[64:65], v[30:31] op_sel_hi:[1,0]
    v_pk_mul_f32 v[66:67], v[66:67], v[30:31] op_sel_hi:[1,0]
    v_pk_mul_f32 v[68:69], v[68:69], v[30:31] op_sel_hi:[1,0]
    v_pk_mul_f32 v[70:71], v[70:71], v[30:31] op_sel_hi:[1,0]
    v_pk_mul_f32 v[72:73], v[72:73], v[30:31] op_sel_hi:[1,0]
    v_pk_mul_f32 v[74:75], v[74:75], v[30:31] op_sel_hi:[1,0]
    v_pk_mul_f32 v[76:77], v[76:77], v[30:31] op_sel_hi:[1,0]
    v_pk_mul_f32 v[78:79], v[78:79], v[30:31] op_sel_hi:[1,0]
    v_pk_mul_f32 v[120:121], v[120:121], v[30:31] op_sel_hi:[1,0]
    v_pk_mul_f32 v[122:123], v[122:123], v[30:31] op_sel_hi:[1,0]
    v_pk_mul_f32 v[124:125], v[124:125], v[30:31] op_sel_hi:[1,0]
    v_pk_mul_f32 v[126:127], v[126:127], v[30:31] op_sel_hi:[1,0]
    v_pk_mul_f32 v[128:129], v[128:129], v[30:31] op_sel_hi:[1,0]
    v_pk_mul_f32 v[130:131], v[130:131], v[30:31] op_sel_hi:[1,0]
    v_pk_mul_f32 v[132:133], v[132:133], v[30:31] op_sel_hi:[1,0]
    v_pk_mul_f32 v[134:135], v[134:135], v[30:31] op_sel_hi:[1,0]
    v_pk_mul_f32 v[136:137], v[136:137], v[30:31] op_sel_hi:[1,0]
    v_pk_mul_f32 v[138:139], v[138:139], v[30:31] op_sel_hi:[1,0]
L1_ns1:
    s_waitcnt lgkmcnt(8)
    v_mfma_f32_16x16x32_bf16 v[96:99], v[216:219], v[8:11], v[96:99]
    ds_read_b64_tr_b16 v[204:205], v174 offset:16384
    ds_read_b64_tr_b16 v[206:207], v174 offset:18432
    v_mfma_f32_16x16x32_bf16 v[156:159], v[216:219], v[12:15], v[156:159]
    v_cvt_pk_bf16_f32 v224, v60, v61
    v_cvt_pk_bf16_f32 v225, v62, v63
    v_cvt_pk_bf16_f32 v226, v64, v65
    v_cvt_pk_bf16_f32 v227, v66, v67
    v_cvt_pk_bf16_f32 v228, v68, v69
    v_cvt_pk_bf16_f32 v229, v70, v71
    s_waitcnt lgkmcnt(8)
    v_mfma_f32_16x16x32_bf16 v[80:83], v[220:223], v[16:19], v[80:83]
    v_mfma_f32_16x16x32_bf16 v[140:143], v[220:223], v[20:23], v[140:143]
    v_cvt_pk_bf16_f32 v230, v72, v73
    v_cvt_pk_bf16_f32 v231, v74, v75
    v_cvt_pk_bf16_f32 v232, v76, v77
    v_cvt_pk_bf16_f32 v233, v78, v79
    v_mov_b32 v234, v25
    v_mov_b32 v235, 0
    s_waitcnt lgkmcnt(6)
    v_mfma_f32_16x16x32_bf16 v[84:87], v[192:195], v[16:19], v[84:87]
    v_mfma_f32_16x16x32_bf16 v[144:147], v[192:195], v[20:23], v[144:147]
    s_mov_b32 s32, 98304
    buffer_store_dwordx4 v[224:227], v34, s[16:19], s32 offen offset:0 sc1
    s_waitcnt lgkmcnt(4)
    v_mfma_f32_16x16x32_bf16 v[88:91], v[196:199], v[16:19], v[88:91]
    v_mfma_f32_16x16x32_bf16 v[148:151], v[196:199], v[20:23], v[148:151]
    s_mov_b32 s32, 131072
    buffer_store_dwordx4 v[228:231], v34, s[16:19], s32 offen offset:0 sc1
    s_waitcnt lgkmcnt(2)
    v_mfma_f32_16x16x32_bf16 v[92:95], v[200:203], v[16:19], v[92:95]
    v_mfma_f32_16x16x32_bf16 v[152:155], v[200:203], v[20:23], v[152:155]
    s_mov_b32 s32, 163840
    buffer_store_dwordx4 v[232:235], v34, s[16:19], s32 offen offset:0 sc1
    s_waitcnt lgkmcnt(0)
    v_mfma_f32_16x16x32_bf16 v[96:99], v[204:207], v[16:19], v[96:99]
    v_mfma_f32_16x16x32_bf16 v[156:159], v[204:207], v[20:23], v[156:159]
    v_cvt_pk_bf16_f32 v236, v120, v121
    v_cvt_pk_bf16_f32 v237, v122, v123
    v_cvt_pk_bf16_f32 v238, v124, v125
    v_cvt_pk_bf16_f32 v239, v126, v127
    v_cvt_pk_bf16_f32 v240, v128, v129
    v_cvt_pk_bf16_f32 v241, v130, v131
    v_cvt_pk_bf16_f32 v242, v132, v133
    v_cvt_pk_bf16_f32 v243, v134, v135
    v_cvt_pk_bf16_f32 v244, v136, v137
    v_cvt_pk_bf16_f32 v245, v138, v139
    v_mov_b32 v246, v25
    v_mov_b32 v247, 0
    s_mov_b32 s32, 98304
    buffer_store_dwordx4 v[236:239], v34, s[16:19], s32 offen offset:256 sc1
    s_mov_b32 s32, 131072
    buffer_store_dwordx4 v[240:243], v34, s[16:19], s32 offen offset:256 sc1
    s_mov_b32 s32, 163840
    buffer_store_dwordx4 v[244:247], v34, s[16:19], s32 offen offset:256 sc1
    s_nop 7
    s_cmp_eq_u32 s33, 0
    s_cbranch_scc1 L1_ns2
    v_pk_mul_f32 v[80:81], v[80:81], v[32:33] op_sel_hi:[1,0]
    v_pk_mul_f32 v[82:83], v[82:83], v[32:33] op_sel_hi:[1,0]
    v_pk_mul_f32 v[84:85], v[84:85], v[32:33] op_sel_hi:[1,0]
    v_pk_mul_f32 v[86:87], v[86:87], v[32:33] op_sel_hi:[1,0]
    v_pk_mul_f32 v[88:89], v[88:89], v[32:33] op_sel_hi:[1,0]
    v_pk_mul_f32 v[90:91], v[90:91], v[32:33] op_sel_hi:[1,0]
    v_pk_mul_f32 v[92:93], v[92:93], v[32:33] op_sel_hi:[1,0]
    v_pk_mul_f32 v[94:95], v[94:95], v[32:33] op_sel_hi:[1,0]
    v_pk_mul_f32 v[96:97], v[96:97], v[32:33] op_sel_hi:[1,0]
    v_pk_mul_f32 v[98:99], v[98:99], v[32:33] op_sel_hi:[1,0]
    v_pk_mul_f32 v[140:141], v[140:141], v[32:33] op_sel_hi:[1,0]
    v_pk_mul_f32 v[142:143], v[142:143], v[32:33] op_sel_hi:[1,0]
    v_pk_mul_f32 v[144:145], v[144:145], v[32:33] op_sel_hi:[1,0]
    v_pk_mul_f32 v[146:147], v[146:147], v[32:33] op_sel_hi:[1,0]
    v_pk_mul_f32 v[148:149], v[148:149], v[32:33] op_sel_hi:[1,0]
    v_pk_mul_f32 v[150:151], v[150:151], v[32:33] op_sel_hi:[1,0]
    v_pk_mul_f32 v[152:153], v[152:153], v[32:33] op_sel_hi:[1,0]
    v_pk_mul_f32 v[154:155], v[154:155], v[32:33] op_sel_hi:[1,0]
    v_pk_mul_f32 v[156:157], v[156:157], v[32:33] op_sel_hi:[1,0]
    v_pk_mul_f32 v[158:159], v[158:159], v[32:33] op_sel_hi:[1,0]
L1_ns2:
    v_cvt_pk_bf16_f32 v224, v80, v81
    v_cvt_pk_bf16_f32 v225, v82, v83
    v_cvt_pk_bf16_f32 v226, v84, v85
    v_cvt_pk_bf16_f32 v227, v86, v87
    v_cvt_pk_bf16_f32 v228, v88, v89
    v_cvt_pk_bf16_f32 v229, v90, v91
    v_cvt_pk_bf16_f32 v230, v92, v93
    v_cvt_pk_bf16_f32 v231, v94, v95
    v_cvt_pk_bf16_f32 v232, v96, v97
    v_cvt_pk_bf16_f32 v233, v98, v99
    v_mov_b32 v234, v26
    v_mov_b32 v235, 0
    s_mov_b32 s32, 196608
    buffer_store_dwordx4 v[224:227], v34, s[16:19], s32 offen offset:0 sc1
    s_mov_b32 s32, 229376
    buffer_store_dwordx4 v[228:231], v34, s[16:19], s32 offen offset:0 sc1
    s_mov_b32 s32, 262144
    buffer_store_dwordx4 v[232:235], v34, s[16:19], s32 offen offset:0 sc1
    v_cvt_pk_bf16_f32 v236, v140, v141
    v_cvt_pk_bf16_f32 v237, v142, v143
    v_cvt_pk_bf16_f32 v238, v144, v145
    v_cvt_pk_bf16_f32 v239, v146, v147
    v_cvt_pk_bf16_f32 v240, v148, v149
    v_cvt_pk_bf16_f32 v241, v150, v151
    v_cvt_pk_bf16_f32 v242, v152, v153
    v_cvt_pk_bf16_f32 v243, v154, v155
    v_cvt_pk_bf16_f32 v244, v156, v157
    v_cvt_pk_bf16_f32 v245, v158, v159
    v_mov_b32 v246, v26
    v_mov_b32 v247, 0
    s_mov_b32 s32, 196608
    buffer_store_dwordx4 v[236:239], v34, s[16:19], s32 offen offset:256 sc1
    s_mov_b32 s32, 229376
    buffer_store_dwordx4 v[240:243], v34, s[16:19], s32 offen offset:256 sc1
    s_mov_b32 s32, 262144
    buffer_store_dwordx4 v[244:247], v34, s[16:19], s32 offen offset:256 sc1
L1_skipst:
L1_join:
    s_lshr_b32 s38, s3, 2
    s_and_b32 s39, s3, 3
    s_lshl_b32 s31, s86, 8
    s_lshl_b32 s44, s39, 6
    s_add_u32 s31, s31, s44
    v_and_b32 v1, 31, v0
    v_lshrrev_b32 v2, 5, v0
    v_add_u32 v3, s31, v1
    v_lshlrev_b32 v3, 4, v3
    v_mul_u32_u24 v238, 32768, v2
    v_add_u32 v238, v238, v3
    v_add_u32 v239, 65536, v3
    s_lshl_b32 s44, s38, 9
    v_add_u32 v236, s44, v238
    v_add_u32 v237, s44, v239
    s_lshl_b32 s44, s38, 5
    s_add_u32 s31, s31, s44
    v_lshlrev_b32 v130, 4, v0
    s_add_u32 s8, s82, 20971520
    s_addc_u32 s9, s83, 0
    s_mov_b32 s10, 5242880
    s_mov_b32 s11, 0x00020000
    s_add_u32 s12, s82, 30408704
    s_addc_u32 s13, s83, 0
    s_mov_b32 s14, 1310720
    s_mov_b32 s15, 0x00020000
    s_add_u32 s24, s82, 27262976
    s_addc_u32 s25, s83, 0
    s_mov_b32 s26, 1638400
    s_mov_b32 s27, 0x00020000
    s_lshl_b32 s30, s85, 3
    s_add_u32 s30, s30, s86
    s_add_u32 s45, s85, 32
    s_mul_i32 s45, s45, 98304
    s_add_u32 s47, s86, 0
    s_mul_hi_u32 s48, s47, 1431655766
    s_mul_i32 s48, s48, 3
    s_sub_u32 s47, s47, s48
    s_mul_i32 s46, s3, 3
    s_add_u32 s46, s46, s47
    s_lshr_b32 s47, s46, 2
    s_and_b32 s46, s46, 3
    s_lshl_b32 s46, s46, 10
    s_cmp_lt_u32 s47, 3
    s_cselect_b32 s48, 0, 3047424
    s_cselect_b32 s49, 0, 4294967104
    s_cselect_b32 s50, 0, 64
    s_add_u32 s50, s50, 4096
    s_mul_i32 s51, s47, 32768
    s_add_u32 s51, s51, s48
    s_add_u32 s51, s51, s45
    s_add_u32 s32, s51, s46
    s_mul_i32 s51, s47, s50
    s_add_u32 s51, s51, s49
    s_add_u32 s35, s51, s46
    s_lshl_b32 s47, s47, 6
    s_add_u32 s47, s47, 12288
    s_add_u32 s59, s35, s47
    s_add_u32 s47, s86, 1
    s_mul_hi_u32 s48, s47, 1431655766
    s_mul_i32 s48, s48, 3
    s_sub_u32 s47, s47, s48
    s_mul_i32 s46, s3, 3
    s_add_u32 s46, s46, s47
    s_lshr_b32 s47, s46, 2
    s_and_b32 s46, s46, 3
    s_lshl_b32 s46, s46, 10
    s_cmp_lt_u32 s47, 3
    s_cselect_b32 s48, 0, 3047424
    s_cselect_b32 s49, 0, 4294967104
    s_cselect_b32 s50, 0, 64
    s_add_u32 s50, s50, 4096
    s_mul_i32 s51, s47, 32768
    s_add_u32 s51, s51, s48
    s_add_u32 s51, s51, s45
    s_add_u32 s33, s51, s46
    s_mul_i32 s51, s47, s50
    s_add_u32 s51, s51, s49
    s_add_u32 s36, s51, s46
    s_lshl_b32 s47, s47, 6
    s_add_u32 s47, s47, 12288
    s_add_u32 s60, s36, s47
    s_add_u32 s47, s86, 2
    s_mul_hi_u32 s48, s47, 1431655766
    s_mul_i32 s48, s48, 3
    s_sub_u32 s47, s47, s48
    s_mul_i32 s46, s3, 3
    s_add_u32 s46, s46, s47
    s_lshr_b32 s47, s46, 2
    s_and_b32 s46, s46, 3
    s_lshl_b32 s46, s46, 10
    s_cmp_lt_u32 s47, 3
    s_cselect_b32 s48, 0, 3047424
    s_cselect_b32 s49, 0, 4294967104
    s_cselect_b32 s50, 0, 64
    s_add_u32 s50, s50, 4096
    s_mul_i32 s51, s47, 32768
    s_add_u32 s51, s51, s48
    s_add_u32 s51, s51, s45
    s_add_u32 s34, s51, s46
    s_mul_i32 s51, s47, s50
    s_add_u32 s51, s51, s49
    s_add_u32 s37, s51, s46
    s_lshl_b32 s47, s47, 6
    s_add_u32 s47, s47, 12288
    s_add_u32 s61, s37, s47
    v_and_b32 v1, 31, v0
    v_lshrrev_b32 v2, 5, v0
    v_and_b32 v3, 19, v1
    v_bfe_u32 v156, v1, 2, 1
    v_lshl_or_b32 v3, v156, 3, v3
    v_bfe_u32 v156, v1, 3, 1
    v_lshl_or_b32 v3, v156, 2, v3
    s_lshl_b32 s44, s38, 5
    v_add_u32 v3, s44, v3
    v_lshlrev_b32 v3, 4, v3
    v_lshl_add_u32 v124, v2, 12, v3
    v_add_u32 v125, 8192, v3
    v_bfe_u32 v156, v0, 2, 2
    v_lshl_add_u32 v156, v2, 3, v156
    v_add_u32 v156, s44, v156
    v_lshlrev_b32 v156, 4, v156
    v_bfe_u32 v157, v0, 4, 1
    v_and_b32 v158, 3, v0
    v_lshl_add_u32 v157, v157, 2, v158
    v_lshrrev_b32 v158, 1, v157
    v_min_u32 v158, 2, v158
    v_and_b32 v157, 1, v157
    v_lshl_add_u32 v156, v157, 3, v156
    v_mul_u32_u24 v159, 4160, v158
    v_add3_u32 v126, v159, v156, 0
    v_add_u32 v126, 12288, v126
    v_bfe_u32 v160, v0, 4, 1
    v_bfe_u32 v161, v0, 1, 1
    v_and_b32 v160, v160, v161
    v_cmp_eq_u32 vcc, 0, v160
    v_add_u32 v161, 137408, v156
    s_nop 0
    v_cndmask_b32 v126, v161, v126, vcc
    v_cndmask_b32 v252, 0, 1, vcc
    s_lshl_b32 s44, s3, 9
    s_add_u32 s44, s44, 137408
    v_lshlrev_b32 v160, 3, v0
    v_add_u32 v160, s44, v160
    v_mov_b32 v162, 0
    v_mov_b32 v163, 0
    ds_write_b64 v160, v[162:163]
    ds_write_b64 v160, v[162:163] offset:512
    s_lshl_b32 s46, s3, 12
    s_add_u32 s46, s46, 99328
    v_bfe_u32 v156, v0, 2, 2
    v_lshl_add_u32 v156, v2, 3, v156
    v_lshlrev_b32 v159, 4, v156
    v_lshl_add_u32 v159, v157, 3, v159
    v_lshl_add_u32 v159, v158, 9, v159
    v_add_u32 v232, s46, v159
    s_add_u32 s46, s46, 1536
    v_mul_u32_u24 v3, 80, v1
    v_mul_u32_u24 v158, 40, v2
    v_add3_u32 v233, v3, v158, s46
    v_mul_u32_u24 v156, 80, v156
    v_and_b32 v158, 1, v0
    v_mul_u32_u24 v158, 40, v158
    v_add_u32 v156, v156, v158
    v_bfe_u32 v158, v0, 4, 1
    v_bfe_u32 v159, v0, 1, 1
    v_lshl_add_u32 v158, v158, 1, v159
    v_lshl_add_u32 v156, v158, 3, v156
    v_add_u32 v234, s46, v156
    v_mov_b32 v12, 0
    v_mov_b32 v13, 0
    v_mov_b32 v14, 0
    v_mov_b32 v15, 0
    v_mov_b32 v16, 0
    v_mov_b32 v17, 0
    v_mov_b32 v18, 0
    v_mov_b32 v19, 0
    v_mov_b32 v136, 0
    v_mov_b32 v137, 0
    v_mov_b32 v138, 0
    v_mov_b32 v139, 0
    v_mov_b32 v20, 0
    v_mov_b32 v21, 0
    v_mov_b32 v22, 0
    v_mov_b32 v23, 0
    v_mov_b32 v24, 0
    v_mov_b32 v25, 0
    v_mov_b32 v26, 0
    v_mov_b32 v27, 0
    v_mov_b32 v28, 0
    v_mov_b32 v29, 0
    v_mov_b32 v30, 0
    v_mov_b32 v31, 0
    v_mov_b32 v32, 0
    v_mov_b32 v33, 0
    v_mov_b32 v34, 0
    v_mov_b32 v35, 0
    v_mov_b32 v36, 0
    v_mov_b32 v37, 0
    v_mov_b32 v38, 0
    v_mov_b32 v39, 0
    v_mov_b32 v40, 0
    v_mov_b32 v41, 0
    v_mov_b32 v42, 0
    v_mov_b32 v43, 0
    v_mov_b32 v44, 0
    v_mov_b32 v45, 0
    v_mov_b32 v46, 0
    v_mov_b32 v47, 0
    v_mov_b32 v48, 0
    v_mov_b32 v49, 0
    v_mov_b32 v50, 0
    v_mov_b32 v51, 0
    v_mov_b32 v88, 0
    v_mov_b32 v89, 0
    v_mov_b32 v90, 0
    v_mov_b32 v91, 0
    v_mov_b32 v116, 0
    v_mov_b32 v117, 0
    v_mov_b32 v118, 0
    v_mov_b32 v119, 0
    v_mov_b32 v120, 0
    v_mov_b32 v121, 0
    v_mov_b32 v122, 0
    v_mov_b32 v123, 0
    v_mov_b32 v188, 0
    v_mov_b32 v189, 0
    v_mov_b32 v190, 0
    v_mov_b32 v191, 0
    v_add_u32 v3, s31, v1
    v_lshrrev_b32 v156, 4, v3
    v_mul_u32_u24 v156, 20480, v156
    v_and_b32 v3, 15, v3
    v_lshl_add_u32 v156, v3, 4, v156
    s_lshr_b32 s44, s85, 1
    s_mul_i32 s44, s44, 5
    s_and_b32 s45, s85, 1
    s_lshl_b32 s46, s45, 1
    s_add_u32 s46, s46, s44
    v_add_u32 v3, s46, v2
    v_lshl_add_u32 v235, v3, 8, v156
    s_add_u32 s44, s44, 4
    s_lshl_b32 s44, s44, 8
    s_lshl_b32 s45, s45, 3
    s_add_u32 s44, s44, s45
    v_add_u32 v131, s44, v156
    s_and_b32 s44, s2, 7
    s_lshr_b32 s45, s2, 3
    s_lshr_b32 s56, s44, 2
    s_and_b32 s57, s44, 3
    s_lshl_b32 s57, s57, 2
    s_lshr_b32 s46, s45, 3
    s_add_u32 s57, s57, s46
    s_and_b32 s58, s45, 7
    v_mov_b32 v250, 0
    s_cmp_eq_u32 s3, 0
    s_cbranch_scc0 L2_nopl
    s_lshl_b32 s46, s85, 3
    v_add_u32 v250, s46, v0
    s_lshl_b32 s46, s56, 3
    s_add_u32 s46, s46, s58
    s_mul_i32 s46, s46, 20
    v_subrev_u32 v158, 8, v0
    v_add_u32 v158, s46, v158
    v_and_b32 v158, 255, v158
    v_cmp_gt_u32 vcc, 8, v0
    s_nop 1
    v_cndmask_b32 v250, v158, v250, vcc
    v_lshlrev_b32 v250, 7, v250
    v_add_u32 v250, 65536, v250
L2_nopl:
    v_subrev_u32 v3, 2, v1
    v_cmp_gt_u32 vcc, 18, v1
    v_and_b32 v156, 30, v1
    s_nop 0
    v_cndmask_b32 v3, v3, v1, vcc
    v_cmp_gt_u32 s[46:47], 18, v1
    v_cmp_eq_u32 vcc, 20, v156
    v_and_b32 v3, 31, v3
    v_lshlrev_b32 v3, 1, v3
    s_or_b64 s[46:47], s[46:47], vcc
    v_mul_u32_u24 v156, 320, v2
    v_add3_u32 v156, v156, v3, 0
    v_add_u32 v156, 147456, v156
    v_add_u32 v157, 148096, v3
    ds_read_u16 v160, v156 offset:0
    ds_read_u16 v161, v156 offset:40
    ds_read_u16 v162, v156 offset:80
    ds_read_u16 v163, v156 offset:120
    ds_read_u16 v164, v156 offset:160
    ds_read_u16 v165, v156 offset:200
    ds_read_u16 v166, v156 offset:240
    ds_read_u16 v167, v156 offset:280
    ds_read_u16 v168, v157 offset:0
    ds_read_u16 v169, v157 offset:40
    ds_read_u16 v170, v157 offset:80
    ds_read_u16 v171, v157 offset:120
    v_cmp_eq_u32 vcc, 0, v2
    s_nop 1
    s_and_b64 vcc, vcc, s[46:47]
    s_waitcnt lgkmcnt(0)
    v_lshl_or_b32 v240, v161, 16, v160
    v_cndmask_b32 v240, 0, v240, s[46:47]
    v_lshl_or_b32 v241, v163, 16, v162
    v_cndmask_b32 v241, 0, v241, s[46:47]
    v_lshl_or_b32 v242, v165, 16, v164
    v_cndmask_b32 v242, 0, v242, s[46:47]
    v_lshl_or_b32 v243, v167, 16, v166
    v_cndmask_b32 v243, 0, v243, s[46:47]
    v_lshl_or_b32 v244, v169, 16, v168
    v_cndmask_b32 v244, 0, v244, vcc
    v_lshl_or_b32 v245, v171, 16, v170
    v_cndmask_b32 v245, 0, v245, vcc
    v_mov_b32 v246, 0
    v_mov_b32 v247, 0
    s_mov_b32 s44, 0x3fb8aa3b
    v_lshlrev_b32 v156, 16, v240
    v_and_b32 v157, 0xffff0000, v240
    v_mul_f32 v156, s44, v156
    v_mul_f32 v157, s44, v157
    v_cvt_pk_bf16_f32 v240, v156, v157
    v_lshlrev_b32 v156, 16, v241
    v_and_b32 v157, 0xffff0000, v241
    v_mul_f32 v156, s44, v156
    v_mul_f32 v157, s44, v157
    v_cvt_pk_bf16_f32 v241, v156, v157
    v_lshlrev_b32 v156, 16, v242
    v_and_b32 v157, 0xffff0000, v242
    v_mul_f32 v156, s44, v156
    v_mul_f32 v157, s44, v157
    v_cvt_pk_bf16_f32 v242, v156, v157
    v_lshlrev_b32 v156, 16, v243
    v_and_b32 v157, 0xffff0000, v243
    v_mul_f32 v156, s44, v156
    v_mul_f32 v157, s44, v157
    v_cvt_pk_bf16_f32 v243, v156, v157
    v_lshlrev_b32 v156, 16, v244
    v_and_b32 v157, 0xffff0000, v244
    v_mul_f32 v156, s44, v156
    v_mul_f32 v157, s44, v157
    v_cvt_pk_bf16_f32 v244, v156, v157
    v_lshlrev_b32 v156, 16, v245
    v_and_b32 v157, 0xffff0000, v245
    v_mul_f32 v156, s44, v156
    v_mul_f32 v157, s44, v157
    v_cvt_pk_bf16_f32 v245, v156, v157
    v_mov_b32 v248, 0x40000000
    v_mov_b32 v249, 0x40000000
    s_cmp_lt_u32 s3, 5
    s_cbranch_scc0 L2_nowoa
    s_add_u32 s44, s30, 0
    s_cmp_ge_u32 s44, 160
    s_cselect_b32 s45, 160, 0
    s_sub_u32 s45, s44, s45
    s_mul_hi_u32 s46, s45, 214748365
    s_mul_i32 s47, s46, 20
    s_sub_u32 s47, s45, s47
    s_lshl_b32 s47, s47, 2
    s_mul_i32 s46, s46, 160
    s_lshl_b32 s48, s3, 6
    v_add_u32 v3, s48, v0
    v_mul_u32_u24 v156, 52429, v3
    v_lshrrev_b32 v156, 19, v156
    v_mul_u32_u24 v157, 10, v156
    v_sub_u32 v157, v3, v157
    v_lshrrev_b32 v158, 3, v156
    v_and_b32 v156, 7, v156
    v_add_u32 v158, s47, v158
    v_mul_u32_u24 v159, 52429, v158
    v_lshrrev_b32 v159, 18, v159
    v_mul_u32_u24 v160, 5, v159
    v_sub_u32 v160, v158, v160
    v_lshrrev_b32 v161, 1, v160
    v_mul_u32_u24 v161, 20, v161
    v_and_b32 v162, 1, v160
    v_lshl_add_u32 v161, v162, 3, v161
    v_cmp_gt_u32 vcc, 4, v156
    v_mov_b32 v162, 32
    s_nop 0
    v_cndmask_b32 v162, v162, 16, vcc
    v_cmp_eq_u32 vcc, 4, v160
    s_nop 1
    v_cndmask_b32 v161, v161, v162, vcc
    v_mul_u32_u24 v159, 40, v159
    v_add3_u32 v161, v161, v159, v156
    v_mul_u32_u24 v161, 1280, v161
    v_lshl_add_u32 v161, v157, 4, v161
    v_add_u32 v248, s46, v161
    s_cmp_ge_u32 s44, 320
    s_cselect_b32 s45, 0x40000000, 0
    v_add_u32 v248, s45, v248
    s_add_u32 s44, s30, 256
    s_cmp_ge_u32 s44, 160
    s_cselect_b32 s45, 160, 0
    s_sub_u32 s45, s44, s45
    s_mul_hi_u32 s46, s45, 214748365
    s_mul_i32 s47, s46, 20
    s_sub_u32 s47, s45, s47
    s_lshl_b32 s47, s47, 2
    s_mul_i32 s46, s46, 160
    s_lshl_b32 s48, s3, 6
    v_add_u32 v3, s48, v0
    v_mul_u32_u24 v156, 52429, v3
    v_lshrrev_b32 v156, 19, v156
    v_mul_u32_u24 v157, 10, v156
    v_sub_u32 v157, v3, v157
    v_lshrrev_b32 v158, 3, v156
    v_and_b32 v156, 7, v156
    v_add_u32 v158, s47, v158
    v_mul_u32_u24 v159, 52429, v158
    v_lshrrev_b32 v159, 18, v159
    v_mul_u32_u24 v160, 5, v159
    v_sub_u32 v160, v158, v160
    v_lshrrev_b32 v161, 1, v160
    v_mul_u32_u24 v161, 20, v161
    v_and_b32 v162, 1, v160
    v_lshl_add_u32 v161, v162, 3, v161
    v_cmp_gt_u32 vcc, 4, v156
    v_mov_b32 v162, 32
    s_nop 0
    v_cndmask_b32 v162, v162, 16, vcc
    v_cmp_eq_u32 vcc, 4, v160
    s_nop 1
    v_cndmask_b32 v161, v161, v162, vcc
    v_mul_u32_u24 v159, 40, v159
    v_add3_u32 v161, v161, v159, v156
    v_mul_u32_u24 v161, 1280, v161
    v_lshl_add_u32 v161, v157, 4, v161
    v_add_u32 v249, s46, v161
    s_cmp_ge_u32 s44, 320
    s_cselect_b32 s45, 0x40000000, 0
    v_add_u32 v249, s45, v249
L2_nowoa:
    v_mov_b32 v194, 0
    s_cmp_eq_u32 s3, 4
    s_cbranch_scc0 L2_nodep
    s_add_u32 s46, s85, 32
    s_mul_hi_u32 s46, s46, 357913942
    s_add_u32 s47, s85, 64
    s_mul_hi_u32 s47, s47, 357913942
    s_mul_hi_u32 s48, s85, 357913942
    s_lshl_b32 s46, s46, 4
    s_lshl_b32 s47, s47, 4
    s_lshl_b32 s48, s48, 4
    s_lshl_b32 s49, s86, 1
    v_and_b32 v194, 15, v0
    v_mov_b32 v195, s46
    v_mov_b32 v196, s47
    v_cmp_gt_u32 vcc, 16, v0
    s_nop 1
    v_cndmask_b32 v195, v196, v195, vcc
    v_add_u32 v194, v194, v195
    v_subrev_u32 v195, 32, v0
    v_lshrrev_b32 v196, 1, v195
    v_and_b32 v195, 1, v195
    v_add_u32 v195, s49, v195
    v_mov_b32 v197, s48
    s_add_u32 s50, s48, 128
    v_mov_b32 v198, s50
    v_cmp_eq_u32 vcc, 1, v196
    s_nop 1
    v_cndmask_b32 v197, v197, v198, vcc
    s_add_u32 s50, s46, 128
    v_mov_b32 v198, s50
    v_cmp_eq_u32 vcc, 2, v196
    s_nop 1
    v_cndmask_b32 v197, v197, v198, vcc
    s_add_u32 s50, s47, 128
    v_mov_b32 v198, s50
    v_cmp_eq_u32 vcc, 3, v196
    s_nop 1
    v_cndmask_b32 v197, v197, v198, vcc
    v_add_u32 v195, v195, v197
    v_cmp_gt_u32 vcc, 32, v0
    s_nop 1
    v_cndmask_b32 v194, v195, v194, vcc
    v_lshlrev_b32 v194, 7, v194
L2_nodep:
    s_cmp_eq_u32 s3, 4
    s_cbranch_scc0 L2_nonw
    v_mov_b32 v152, 147328
    v_mov_b32 v153, s84
    ds_write_b32 v152, v153
L2_nonw:
    s_waitcnt vmcnt(0) lgkmcnt(0)
    s_barrier
    s_cmp_eq_u32 s3, 4
    s_cbranch_scc0 L2_nosync1
    s_lshl_b32 s44, s62, 7
    s_add_u32 s44, s44, 0
    v_mov_b32 v152, s44
    v_mov_b32 v153, s84
    s_mov_b64 exec, 1
    buffer_store_dword v153, v152, s[96:99], 0 offen sc1
    s_mov_b64 exec, -1
    s_mov_b32 s44, 0
L_poll_s1:
    s_mov_b32 exec_hi, 0xff
    buffer_load_dword v195, v194, s[96:99], 0 offen sc1
    s_waitcnt vmcnt(0)
    v_cmp_ne_u32 vcc, s84, v195
    s_mov_b64 exec, -1
    s_add_u32 s44, s44, 1
    s_cbranch_vccz L_polldone_s1
    s_cmp_lt_u32 s44, 0x100000
    s_cbranch_scc0 L_polldone_s1
    s_branch L_poll_s1
L_polldone_s1:
    s_branch L2_sync1d
L2_nosync1:
    v_mov_b32 v152, 147328
    ds_read_b32 v153, v152
    s_waitcnt lgkmcnt(0)
    v_readfirstlane_b32 s84, v153
L2_sync1d:
    s_barrier
    s_add_u32 m0, s35, 0
    s_add_u32 s44, s32, 0
    buffer_load_dwordx4 v130, s[16:19], s44 offen sc1 lds
    s_add_u32 m0, s36, 0
    s_add_u32 s44, s33, 0
    buffer_load_dwordx4 v130, s[16:19], s44 offen sc1 lds
    s_add_u32 m0, s37, 0
    s_add_u32 s44, s34, 0
    buffer_load_dwordx4 v130, s[16:19], s44 offen sc1 lds
    s_mul_i32 s45, s85, 98304
    buffer_load_dwordx4 v[4:7], v238, s[16:19], s45 offen offset:0 sc1
    s_mov_b32 exec_hi, 0
    buffer_load_dwordx4 v[12:15], v239, s[16:19], s45 offen offset:0 sc1
    s_mov_b64 exec, -1
    buffer_load_dwordx4 v[8:11], v238, s[16:19], s45 offen offset:512 sc1
    s_mov_b32 exec_hi, 0
    buffer_load_dwordx4 v[16:19], v239, s[16:19], s45 offen offset:512 sc1
    s_mov_b64 exec, -1
    s_waitcnt vmcnt(0)
    s_barrier
    ds_read_b128 v[92:95], v124 offset:0
    ds_read_b64 v[100:101], v125 offset:0
    ds_read_b64_tr_b16 v[108:109], v126 offset:0
    ds_read_b64_tr_b16 v[110:111], v126 offset:64
    ds_read_b64_tr_b16 v[112:113], v126 offset:256
    ds_read_b64_tr_b16 v[114:115], v126 offset:320
    s_waitcnt lgkmcnt(0)
    v_mfma_f32_32x32x16_bf16 v[52:67], v[92:95], v[4:7], 0
    v_mfma_f32_32x32x8_bf16 v[52:67], v[100:101], v[12:13], v[52:67]
    s_add_u32 m0, s35, 24832
    s_add_u32 s44, s32, 4096
    buffer_load_dwordx4 v130, s[16:19], s44 offen sc1 lds
    s_add_u32 m0, s36, 24832
    s_add_u32 s44, s33, 4096
    buffer_load_dwordx4 v130, s[16:19], s44 offen sc1 lds
    s_add_u32 m0, s37, 24832
    s_add_u32 s44, s34, 4096
    buffer_load_dwordx4 v130, s[16:19], s44 offen sc1 lds
    s_add_u32 s46, s85, 160
    s_mul_i32 s46, s46, 98304
    s_lshl_b32 s47, s3, 12
    s_add_u32 s47, s47, 99328
    s_mov_b32 m0, s47
    s_sub_u32 s48, s46, 1024
    buffer_load_dwordx4 v236, s[16:19], s46 offen sc1 lds
    s_mov_b32 exec_hi, 0
    buffer_load_dwordx4 v237, s[16:19], s48 offen offset:1024 sc1 lds
    s_mov_b64 exec, -1
    s_cmp_eq_u32 s38, 0
    s_cbranch_scc0 L2_norows
    s_add_u32 s45, s85, 128
    s_mul_i32 s45, s45, 98304
    buffer_load_dwordx4 v[132:135], v236, s[16:19], s45 offen offset:0 sc1
    s_mov_b32 exec_hi, 0
    buffer_load_dwordx4 v[136:139], v237, s[16:19], s45 offen offset:0 sc1
    s_mov_b64 exec, -1
    s_add_u32 s45, s85, 96
    s_mul_i32 s45, s45, 98304
    buffer_load_dwordx4 v[184:187], v236, s[16:19], s45 offen offset:0 sc1
    s_mov_b32 exec_hi, 0
    buffer_load_dwordx4 v[188:191], v237, s[16:19], s45 offen offset:0 sc1
    s_mov_b64 exec, -1
L2_norows:
    s_mov_b32 s42, 0
    s_mov_b32 s95, 8192
    s_mov_b32 s94, 49664
    s_mov_b32 s40, 247
    s_cmp_eq_u32 s3, 0
    s_cselect_b32 s40, 0xff, s40
    s_cmp_eq_u32 s3, 4
    s_cselect_b32 s40, 1, s40
    s_cmp_ge_u32 s3, 5
    s_cselect_b32 s40, 0, s40
    s_cmp_eq_u32 s3, 0
    s_cselect_b32 s41, 4, 255
    s_cmp_eq_u32 s38, 0
    s_cselect_b32 s53, 6, 0
    s_nop 7
    s_mov_b32 s43, 24832
    s_mov_b32 s63, 4294892800
    s_cmp_eq_u32 s38, 0
    s_cbranch_scc0 L2_loop1_pre
.p2align 6
L2_loop0:
    v_mfma_f32_32x32x16_bf16 v[68:83], v[92:95], v[8:11], 0
    ds_read_b128 v[96:99], v124 offset:1024
    ds_read_b64 v[104:105], v125 offset:1024
    v_exp_f32 v52, v52
    v_exp_f32 v53, v53
    v_exp_f32 v54, v54
    v_exp_f32 v55, v55
    v_cvt_pk_bf16_f32 v84, v52, v53
    v_mfma_f32_32x32x16_bf16 v[36:51], v[120:123], v[88:91], v[36:51]
    v_exp_f32 v56, v56
    v_cvt_pk_bf16_f32 v85, v54, v55
    v_exp_f32 v57, v57
    v_exp_f32 v58, v58
    v_exp_f32 v59, v59
    v_cvt_pk_bf16_f32 v86, v56, v57
    v_mfma_f32_32x32x8_bf16 v[68:83], v[100:101], v[16:17], v[68:83]
    ds_read_b64_tr_b16 v[116:117], v126 offset:1024
    ds_read_b64_tr_b16 v[118:119], v126 offset:1088
    ds_read_b64_tr_b16 v[120:121], v126 offset:1280
    ds_read_b64_tr_b16 v[122:123], v126 offset:1344
    v_exp_f32 v60, v60
    v_cvt_pk_bf16_f32 v87, v58, v59
    v_exp_f32 v61, v61
    v_exp_f32 v62, v62
    v_exp_f32 v63, v63
    v_cvt_pk_bf16_f32 v88, v60, v61
    v_mfma_f32_32x32x16_bf16 v[20:35], v[108:111], v[84:87], v[20:35]
    v_exp_f32 v64, v64
    v_cvt_pk_bf16_f32 v89, v62, v63
    v_exp_f32 v65, v65
    v_exp_f32 v66, v66
    v_exp_f32 v67, v67
    v_cvt_pk_bf16_f32 v90, v64, v65
    v_cvt_pk_bf16_f32 v91, v66, v67
    s_waitcnt lgkmcnt(0)
    v_mfma_f32_32x32x16_bf16 v[52:67], v[96:99], v[4:7], 0
    v_exp_f32 v68, v68
    v_exp_f32 v69, v69
    v_exp_f32 v70, v70
    v_exp_f32 v71, v71
    v_cvt_pk_bf16_f32 v84, v68, v69
    v_mfma_f32_32x32x16_bf16 v[20:35], v[112:115], v[88:91], v[20:35]
    v_exp_f32 v72, v72
    v_cvt_pk_bf16_f32 v85, v70, v71
    v_exp_f32 v73, v73
    v_exp_f32 v74, v74
    v_exp_f32 v75, v75
    v_cvt_pk_bf16_f32 v86, v72, v73
    v_mfma_f32_32x32x8_bf16 v[52:67], v[104:105], v[12:13], v[52:67]
    v_exp_f32 v76, v76
    v_cvt_pk_bf16_f32 v87, v74, v75
    v_exp_f32 v77, v77
    v_exp_f32 v78, v78
    v_exp_f32 v79, v79
    v_cvt_pk_bf16_f32 v88, v76, v77
    v_mfma_f32_32x32x16_bf16 v[36:51], v[108:111], v[84:87], v[36:51]
    v_exp_f32 v80, v80
    v_cvt_pk_bf16_f32 v89, v78, v79
    v_exp_f32 v81, v81
    v_exp_f32 v82, v82
    v_exp_f32 v83, v83
    v_cvt_pk_bf16_f32 v90, v80, v81
    v_cvt_pk_bf16_f32 v91, v82, v83
    v_mfma_f32_32x32x16_bf16 v[68:83], v[96:99], v[8:11], 0
    ds_read_b128 v[92:95], v124 offset:2048
    ds_read_b64 v[100:101], v125 offset:2048
    v_exp_f32 v52, v52
    v_exp_f32 v53, v53
    v_exp_f32 v54, v54
    v_exp_f32 v55, v55
    v_cvt_pk_bf16_f32 v84, v52, v53
    v_mfma_f32_32x32x16_bf16 v[36:51], v[112:115], v[88:91], v[36:51]
    v_exp_f32 v56, v56
    v_cvt_pk_bf16_f32 v85, v54, v55
    v_exp_f32 v57, v57
    v_exp_f32 v58, v58
    v_exp_f32 v59, v59
    v_cvt_pk_bf16_f32 v86, v56, v57
    v_mfma_f32_32x32x8_bf16 v[68:83], v[104:105], v[16:17], v[68:83]
    ds_read_b64_tr_b16 v[108:109], v126 offset:2048
    ds_read_b64_tr_b16 v[110:111], v126 offset:2112
    ds_read_b64_tr_b16 v[112:113], v126 offset:2304
    ds_read_b64_tr_b16 v[114:115], v126 offset:2368
    v_exp_f32 v60, v60
    v_cvt_pk_bf16_f32 v87, v58, v59
    v_exp_f32 v61, v61
    v_exp_f32 v62, v62
    v_exp_f32 v63, v63
    v_cvt_pk_bf16_f32 v88, v60, v61
    v_mfma_f32_32x32x16_bf16 v[20:35], v[116:119], v[84:87], v[20:35]
    v_exp_f32 v64, v64
    v_cvt_pk_bf16_f32 v89, v62, v63
    v_exp_f32 v65, v65
    v_exp_f32 v66, v66
    v_exp_f32 v67, v67
    v_cvt_pk_bf16_f32 v90, v64, v65
    v_cvt_pk_bf16_f32 v91, v66, v67
    s_waitcnt lgkmcnt(0)
    v_mfma_f32_32x32x16_bf16 v[52:67], v[92:95], v[4:7], 0
    v_exp_f32 v68, v68
    v_exp_f32 v69, v69
    v_exp_f32 v70, v70
    v_exp_f32 v71, v71
    v_cvt_pk_bf16_f32 v84, v68, v69
    v_mfma_f32_32x32x16_bf16 v[20:35], v[120:123], v[88:91], v[20:35]
    v_exp_f32 v72, v72
    v_cvt_pk_bf16_f32 v85, v70, v71
    v_exp_f32 v73, v73
    v_exp_f32 v74, v74
    v_exp_f32 v75, v75
    v_cvt_pk_bf16_f32 v86, v72, v73
    v_mfma_f32_32x32x8_bf16 v[52:67], v[100:101], v[12:13], v[52:67]
    v_exp_f32 v76, v76
    v_cvt_pk_bf16_f32 v87, v74, v75
    v_exp_f32 v77, v77
    v_exp_f32 v78, v78
    v_exp_f32 v79, v79
    v_cvt_pk_bf16_f32 v88, v76, v77
    v_mfma_f32_32x32x16_bf16 v[36:51], v[116:119], v[84:87], v[36:51]
    v_exp_f32 v80, v80
    v_cvt_pk_bf16_f32 v89, v78, v79
    v_exp_f32 v81, v81
    v_exp_f32 v82, v82
    v_exp_f32 v83, v83
    v_cvt_pk_bf16_f32 v90, v80, v81
    v_cvt_pk_bf16_f32 v91, v82, v83
    v_mfma_f32_32x32x16_bf16 v[68:83], v[92:95], v[8:11], 0
    ds_read_b128 v[96:99], v124 offset:3072
    ds_read_b64 v[104:105], v125 offset:3072
    v_exp_f32 v52, v52
    v_exp_f32 v53, v53
    v_exp_f32 v54, v54
    v_exp_f32 v55, v55
    v_cvt_pk_bf16_f32 v84, v52, v53
    v_mfma_f32_32x32x16_bf16 v[36:51], v[120:123], v[88:91], v[36:51]
    v_exp_f32 v56, v56
    v_cvt_pk_bf16_f32 v85, v54, v55
    v_exp_f32 v57, v57
    v_exp_f32 v58, v58
    v_exp_f32 v59, v59
    v_cvt_pk_bf16_f32 v86, v56, v57
    v_mfma_f32_32x32x8_bf16 v[68:83], v[100:101], v[16:17], v[68:83]
    ds_read_b64_tr_b16 v[116:117], v126 offset:3072
    ds_read_b64_tr_b16 v[118:119], v126 offset:3136
    ds_read_b64_tr_b16 v[120:121], v126 offset:3328
    ds_read_b64_tr_b16 v[122:123], v126 offset:3392
    v_exp_f32 v60, v60
    v_cvt_pk_bf16_f32 v87, v58, v59
    v_exp_f32 v61, v61
    v_exp_f32 v62, v62
    v_exp_f32 v63, v63
    v_cvt_pk_bf16_f32 v88, v60, v61
    v_mfma_f32_32x32x16_bf16 v[20:35], v[108:111], v[84:87], v[20:35]
    v_exp_f32 v64, v64
    v_cvt_pk_bf16_f32 v89, v62, v63
    v_exp_f32 v65, v65
    v_exp_f32 v66, v66
    v_exp_f32 v67, v67
    v_cvt_pk_bf16_f32 v90, v64, v65
    v_cvt_pk_bf16_f32 v91, v66, v67
    s_waitcnt lgkmcnt(0)
    v_mfma_f32_32x32x16_bf16 v[52:67], v[96:99], v[4:7], 0
    v_exp_f32 v68, v68
    v_exp_f32 v69, v69
    v_exp_f32 v70, v70
    v_exp_f32 v71, v71
    v_cvt_pk_bf16_f32 v84, v68, v69
    v_mfma_f32_32x32x16_bf16 v[20:35], v[112:115], v[88:91], v[20:35]
    v_exp_f32 v72, v72
    v_cvt_pk_bf16_f32 v85, v70, v71
    v_exp_f32 v73, v73
    v_exp_f32 v74, v74
    v_exp_f32 v75, v75
    v_cvt_pk_bf16_f32 v86, v72, v73
    v_mfma_f32_32x32x8_bf16 v[52:67], v[104:105], v[12:13], v[52:67]
    v_exp_f32 v76, v76
    v_cvt_pk_bf16_f32 v87, v74, v75
    v_exp_f32 v77, v77
    v_exp_f32 v78, v78
    v_exp_f32 v79, v79
    v_cvt_pk_bf16_f32 v88, v76, v77
    v_mfma_f32_32x32x16_bf16 v[36:51], v[108:111], v[84:87], v[36:51]
    v_exp_f32 v80, v80
    v_cvt_pk_bf16_f32 v89, v78, v79
    v_exp_f32 v81, v81
    v_exp_f32 v82, v82
    v_exp_f32 v83, v83
    v_cvt_pk_bf16_f32 v90, v80, v81
    v_cvt_pk_bf16_f32 v91, v82, v83
    s_cmp_eq_u32 s42, s41
    s_cbranch_scc1 L2_pre
L2_preret:
    s_waitcnt vmcnt(0)
    s_barrier
    s_and_b32 s44, s42, 3
    s_cmp_eq_u32 s44, 3
    s_cselect_b32 s44, s63, s43
    v_add_u32 v124, s44, v124
    v_add_u32 v125, s44, v125
    v_mad_i32_i24 v126, v252, s44, v126
    s_bitcmp1_b32 s40, s42
    s_cbranch_scc1 L2_payload
L2_secret0:
    v_mfma_f32_32x32x16_bf16 v[68:83], v[96:99], v[8:11], 0
    ds_read_b128 v[92:95], v124 offset:0
    ds_read_b64 v[100:101], v125 offset:0
    v_exp_f32 v52, v52
    v_exp_f32 v53, v53
    v_exp_f32 v54, v54
    v_exp_f32 v55, v55
    v_cvt_pk_bf16_f32 v84, v52, v53
    v_mfma_f32_32x32x16_bf16 v[36:51], v[112:115], v[88:91], v[36:51]
    v_exp_f32 v56, v56
    v_cvt_pk_bf16_f32 v85, v54, v55
    v_exp_f32 v57, v57
    v_exp_f32 v58, v58
    v_exp_f32 v59, v59
    v_cvt_pk_bf16_f32 v86, v56, v57
    v_mfma_f32_32x32x8_bf16 v[68:83], v[104:105], v[16:17], v[68:83]
    ds_read_b64_tr_b16 v[108:109], v126 offset:0
    ds_read_b64_tr_b16 v[110:111], v126 offset:64
    ds_read_b64_tr_b16 v[112:113], v126 offset:256
    ds_read_b64_tr_b16 v[114:115], v126 offset:320
    v_exp_f32 v60, v60
    v_cvt_pk_bf16_f32 v87, v58, v59
    v_exp_f32 v61, v61
    v_exp_f32 v62, v62
    v_exp_f32 v63, v63
    v_cvt_pk_bf16_f32 v88, v60, v61
    v_mfma_f32_32x32x16_bf16 v[20:35], v[116:119], v[84:87], v[20:35]
    s_cmp_lt_u32 s42, 6
    s_cbranch_scc0 L2_nd0
    s_add_u32 m0, s35, s94
    s_add_u32 s44, s32, s95
    buffer_load_dwordx4 v130, s[16:19], s44 offen sc1 lds
    s_add_u32 m0, s36, s94
    s_add_u32 s44, s33, s95
    buffer_load_dwordx4 v130, s[16:19], s44 offen sc1 lds
    s_add_u32 m0, s37, s94
    s_add_u32 s44, s34, s95
    buffer_load_dwordx4 v130, s[16:19], s44 offen sc1 lds
L2_nd0:
    v_exp_f32 v64, v64
    v_cvt_pk_bf16_f32 v89, v62, v63
    v_exp_f32 v65, v65
    v_exp_f32 v66, v66
    v_exp_f32 v67, v67
    v_cvt_pk_bf16_f32 v90, v64, v65
    v_cvt_pk_bf16_f32 v91, v66, v67
    s_waitcnt lgkmcnt(0)
    v_mfma_f32_32x32x16_bf16 v[52:67], v[92:95], v[4:7], 0
    v_exp_f32 v68, v68
    v_exp_f32 v69, v69
    v_exp_f32 v70, v70
    v_exp_f32 v71, v71
    v_cvt_pk_bf16_f32 v84, v68, v69
    v_mfma_f32_32x32x16_bf16 v[20:35], v[120:123], v[88:91], v[20:35]
    s_cmp_lt_u32 s42, 6
    s_cbranch_scc0 L2_nd1
    s_add_u32 m0, s59, s94
    s_add_u32 s44, s32, s95
    s_add_u32 s44, s44, 3145728
    buffer_load_dwordx4 v130, s[16:19], s44 offen sc1 lds
    s_add_u32 m0, s60, s94
    s_add_u32 s44, s33, s95
    s_add_u32 s44, s44, 3145728
    buffer_load_dwordx4 v130, s[16:19], s44 offen sc1 lds
    s_add_u32 m0, s61, s94
    s_add_u32 s44, s34, s95
    s_add_u32 s44, s44, 3145728
    buffer_load_dwordx4 v130, s[16:19], s44 offen sc1 lds
L2_nd1:
    v_exp_f32 v72, v72
    v_cvt_pk_bf16_f32 v85, v70, v71
    v_exp_f32 v73, v73
    v_exp_f32 v74, v74
    v_exp_f32 v75, v75
    v_cvt_pk_bf16_f32 v86, v72, v73
    v_mfma_f32_32x32x8_bf16 v[52:67], v[100:101], v[12:13], v[52:67]
    v_exp_f32 v76, v76
    v_cvt_pk_bf16_f32 v87, v74, v75
    v_exp_f32 v77, v77
    v_exp_f32 v78, v78
    v_exp_f32 v79, v79
    v_cvt_pk_bf16_f32 v88, v76, v77
    v_mfma_f32_32x32x16_bf16 v[36:51], v[116:119], v[84:87], v[36:51]
    v_exp_f32 v80, v80
    v_cvt_pk_bf16_f32 v89, v78, v79
    v_exp_f32 v81, v81
    v_exp_f32 v82, v82
    v_exp_f32 v83, v83
    v_cvt_pk_bf16_f32 v90, v80, v81
    v_cvt_pk_bf16_f32 v91, v82, v83
    s_add_u32 s95, s95, 4096
    s_add_u32 s94, s94, 24832
    s_cmp_eq_u32 s94, 99328
    s_cselect_b32 s94, 0, s94
    s_add_u32 s42, s42, 1
    s_cmp_lt_u32 s42, 8
    s_cbranch_scc1 L2_loop0
    s_branch L2_tail
L2_loop1_pre:
    s_nop 0
.p2align 6
L2_loop1:
    v_mfma_f32_32x32x16_bf16 v[68:83], v[92:95], v[8:11], 0
    ds_read_b128 v[96:99], v124 offset:1024
    ds_read_b64 v[104:105], v125 offset:1024
    v_exp_f32 v52, v52
    v_exp_f32 v53, v53
    v_exp_f32 v54, v54
    v_exp_f32 v55, v55
    v_cvt_pk_bf16_f32 v84, v52, v53
    v_mfma_f32_32x32x16_bf16 v[36:51], v[120:123], v[88:91], v[36:51]
    v_exp_f32 v56, v56
    v_cvt_pk_bf16_f32 v85, v54, v55
    v_exp_f32 v57, v57
    v_exp_f32 v58, v58
    v_exp_f32 v59, v59
    v_cvt_pk_bf16_f32 v86, v56, v57
    v_mfma_f32_32x32x8_bf16 v[68:83], v[100:101], v[16:17], v[68:83]
    ds_read_b64_tr_b16 v[116:117], v126 offset:1024
    ds_read_b64_tr_b16 v[118:119], v126 offset:1088
    ds_read_b64_tr_b16 v[120:121], v126 offset:1280
    ds_read_b64_tr_b16 v[122:123], v126 offset:1344
    v_exp_f32 v60, v60
    v_cvt_pk_bf16_f32 v87, v58, v59
    v_exp_f32 v61, v61
    v_exp_f32 v62, v62
    v_exp_f32 v63, v63
    v_cvt_pk_bf16_f32 v88, v60, v61
    v_mfma_f32_32x32x16_bf16 v[20:35], v[108:111], v[84:87], v[20:35]
    v_exp_f32 v64, v64
    v_cvt_pk_bf16_f32 v89, v62, v63
    v_exp_f32 v65, v65
    v_exp_f32 v66, v66
    v_exp_f32 v67, v67
    v_cvt_pk_bf16_f32 v90, v64, v65
    v_cvt_pk_bf16_f32 v91, v66, v67
    s_waitcnt lgkmcnt(0)
    v_mfma_f32_32x32x16_bf16 v[52:67], v[96:99], v[4:7], 0
    v_exp_f32 v68, v68
    v_exp_f32 v69, v69
    v_exp_f32 v70, v70
    v_exp_f32 v71, v71
    v_cvt_pk_bf16_f32 v84, v68, v69
    v_mfma_f32_32x32x16_bf16 v[20:35], v[112:115], v[88:91], v[20:35]
    v_exp_f32 v72, v72
    v_cvt_pk_bf16_f32 v85, v70, v71
    v_exp_f32 v73, v73
    v_exp_f32 v74, v74
    v_exp_f32 v75, v75
    v_cvt_pk_bf16_f32 v86, v72, v73
    v_mfma_f32_32x32x8_bf16 v[52:67], v[104:105], v[12:13], v[52:67]
    v_exp_f32 v76, v76
    v_cvt_pk_bf16_f32 v87, v74, v75
    v_exp_f32 v77, v77
    v_exp_f32 v78, v78
    v_exp_f32 v79, v79
    v_cvt_pk_bf16_f32 v88, v76, v77
    v_mfma_f32_32x32x16_bf16 v[36:51], v[108:111], v[84:87], v[36:51]
    v_exp_f32 v80, v80
    v_cvt_pk_bf16_f32 v89, v78, v79
    v_exp_f32 v81, v81
    v_exp_f32 v82, v82
    v_exp_f32 v83, v83
    v_cvt_pk_bf16_f32 v90, v80, v81
    v_cvt_pk_bf16_f32 v91, v82, v83
    v_mfma_f32_32x32x16_bf16 v[68:83], v[96:99], v[8:11], 0
    ds_read_b128 v[92:95], v124 offset:2048
    ds_read_b64 v[100:101], v125 offset:2048
    v_exp_f32 v52, v52
    v_exp_f32 v53, v53
    v_exp_f32 v54, v54
    v_exp_f32 v55, v55
    v_cvt_pk_bf16_f32 v84, v52, v53
    v_mfma_f32_32x32x16_bf16 v[36:51], v[112:115], v[88:91], v[36:51]
    v_exp_f32 v56, v56
    v_cvt_pk_bf16_f32 v85, v54, v55
    v_exp_f32 v57, v57
    v_exp_f32 v58, v58
    v_exp_f32 v59, v59
    v_cvt_pk_bf16_f32 v86, v56, v57
    v_mfma_f32_32x32x8_bf16 v[68:83], v[104:105], v[16:17], v[68:83]
    ds_read_b64_tr_b16 v[108:109], v126 offset:2048
    ds_read_b64_tr_b16 v[110:111], v126 offset:2112
    ds_read_b64_tr_b16 v[112:113], v126 offset:2304
    ds_read_b64_tr_b16 v[114:115], v126 offset:2368
    v_exp_f32 v60, v60
    v_cvt_pk_bf16_f32 v87, v58, v59
    v_exp_f32 v61, v61
    v_exp_f32 v62, v62
    v_exp_f32 v63, v63
    v_cvt_pk_bf16_f32 v88, v60, v61
    v_mfma_f32_32x32x16_bf16 v[20:35], v[116:119], v[84:87], v[20:35]
    v_exp_f32 v64, v64
    v_cvt_pk_bf16_f32 v89, v62, v63
    v_exp_f32 v65, v65
    v_exp_f32 v66, v66
    v_exp_f32 v67, v67
    v_cvt_pk_bf16_f32 v90, v64, v65
    v_cvt_pk_bf16_f32 v91, v66, v67
    s_waitcnt lgkmcnt(0)
    v_mfma_f32_32x32x16_bf16 v[52:67], v[92:95], v[4:7], 0
    v_exp_f32 v68, v68
    v_exp_f32 v69, v69
    v_exp_f32 v70, v70
    v_exp_f32 v71, v71
    v_cvt_pk_bf16_f32 v84, v68, v69
    v_mfma_f32_32x32x16_bf16 v[20:35], v[120:123], v[88:91], v[20:35]
    v_exp_f32 v72, v72
    v_cvt_pk_bf16_f32 v85, v70, v71
    v_exp_f32 v73, v73
    v_exp_f32 v74, v74
    v_exp_f32 v75, v75
    v_cvt_pk_bf16_f32 v86, v72, v73
    v_mfma_f32_32x32x8_bf16 v[52:67], v[100:101], v[12:13], v[52:67]
    v_exp_f32 v76, v76
    v_cvt_pk_bf16_f32 v87, v74, v75
    v_exp_f32 v77, v77
    v_exp_f32 v78, v78
    v_exp_f32 v79, v79
    v_cvt_pk_bf16_f32 v88, v76, v77
    v_mfma_f32_32x32x16_bf16 v[36:51], v[116:119], v[84:87], v[36:51]
    v_exp_f32 v80, v80
    v_cvt_pk_bf16_f32 v89, v78, v79
    v_exp_f32 v81, v81
    v_exp_f32 v82, v82
    v_exp_f32 v83, v83
    v_cvt_pk_bf16_f32 v90, v80, v81
    v_cvt_pk_bf16_f32 v91, v82, v83
    v_mfma_f32_32x32x16_bf16 v[68:83], v[92:95], v[8:11], 0
    ds_read_b128 v[96:99], v124 offset:3072
    ds_read_b64 v[104:105], v125 offset:3072
    v_exp_f32 v52, v52
    v_exp_f32 v53, v53
    v_exp_f32 v54, v54
    v_exp_f32 v55, v55
    v_cvt_pk_bf16_f32 v84, v52, v53
    v_mfma_f32_32x32x16_bf16 v[36:51], v[120:123], v[88:91], v[36:51]
    v_exp_f32 v56, v56
    v_cvt_pk_bf16_f32 v85, v54, v55
    v_exp_f32 v57, v57
    v_exp_f32 v58, v58
    v_exp_f32 v59, v59
    v_cvt_pk_bf16_f32 v86, v56, v57
    v_mfma_f32_32x32x8_bf16 v[68:83], v[100:101], v[16:17], v[68:83]
    ds_read_b64_tr_b16 v[116:117], v126 offset:3072
    ds_read_b64_tr_b16 v[118:119], v126 offset:3136
    ds_read_b64_tr_b16 v[120:121], v126 offset:3328
    ds_read_b64_tr_b16 v[122:123], v126 offset:3392
    v_exp_f32 v60, v60
    v_cvt_pk_bf16_f32 v87, v58, v59
    v_exp_f32 v61, v61
    v_exp_f32 v62, v62
    v_exp_f32 v63, v63
    v_cvt_pk_bf16_f32 v88, v60, v61
    v_mfma_f32_32x32x16_bf16 v[20:35], v[108:111], v[84:87], v[20:35]
    v_exp_f32 v64, v64
    v_cvt_pk_bf16_f32 v89, v62, v63
    v_exp_f32 v65, v65
    v_exp_f32 v66, v66
    v_exp_f32 v67, v67
    v_cvt_pk_bf16_f32 v90, v64, v65
    v_cvt_pk_bf16_f32 v91, v66, v67
    s_waitcnt lgkmcnt(0)
    v_mfma_f32_32x32x16_bf16 v[52:67], v[96:99], v[4:7], 0
    v_exp_f32 v68, v68
    v_exp_f32 v69, v69
    v_exp_f32 v70, v70
    v_exp_f32 v71, v71
    v_cvt_pk_bf16_f32 v84, v68, v69
    v_mfma_f32_32x32x16_bf16 v[20:35], v[112:115], v[88:91], v[20:35]
    v_exp_f32 v72, v72
    v_cvt_pk_bf16_f32 v85, v70, v71
    v_exp_f32 v73, v73
    v_exp_f32 v74, v74
    v_exp_f32 v75, v75
    v_cvt_pk_bf16_f32 v86, v72, v73
    v_mfma_f32_32x32x8_bf16 v[52:67], v[104:105], v[12:13], v[52:67]
    v_exp_f32 v76, v76
    v_cvt_pk_bf16_f32 v87, v74, v75
    v_exp_f32 v77, v77
    v_exp_f32 v78, v78
    v_exp_f32 v79, v79
    v_cvt_pk_bf16_f32 v88, v76, v77
    v_mfma_f32_32x32x16_bf16 v[36:51], v[108:111], v[84:87], v[36:51]
    v_exp_f32 v80, v80
    v_cvt_pk_bf16_f32 v89, v78, v79
    v_exp_f32 v81, v81
    v_exp_f32 v82, v82
    v_exp_f32 v83, v83
    v_cvt_pk_bf16_f32 v90, v80, v81
    v_cvt_pk_bf16_f32 v91, v82, v83
    s_waitcnt vmcnt(0)
    s_barrier
    s_and_b32 s44, s42, 3
    s_cmp_eq_u32 s44, 3
    s_cselect_b32 s44, s63, s43
    v_add_u32 v124, s44, v124
    v_add_u32 v125, s44, v125
    v_mad_i32_i24 v126, v252, s44, v126
    s_bitcmp1_b32 s40, s42
    s_cbranch_scc1 L2_payload
L2_secret1:
    v_mfma_f32_32x32x16_bf16 v[68:83], v[96:99], v[8:11], 0
    ds_read_b128 v[92:95], v124 offset:0
    ds_read_b64 v[100:101], v125 offset:0
    v_exp_f32 v52, v52
    v_exp_f32 v53, v53
    v_exp_f32 v54, v54
    v_exp_f32 v55, v55
    v_cvt_pk_bf16_f32 v84, v52, v53
    v_mfma_f32_32x32x16_bf16 v[36:51], v[112:115], v[88:91], v[36:51]
    v_exp_f32 v56, v56
    v_cvt_pk_bf16_f32 v85, v54, v55
    v_exp_f32 v57, v57
    v_exp_f32 v58, v58
    v_exp_f32 v59, v59
    v_cvt_pk_bf16_f32 v86, v56, v57
    v_mfma_f32_32x32x8_bf16 v[68:83], v[104:105], v[16:17], v[68:83]
    ds_read_b64_tr_b16 v[108:109], v126 offset:0
    ds_read_b64_tr_b16 v[110:111], v126 offset:64
    ds_read_b64_tr_b16 v[112:113], v126 offset:256
    ds_read_b64_tr_b16 v[114:115], v126 offset:320
    v_exp_f32 v60, v60
    v_cvt_pk_bf16_f32 v87, v58, v59
    v_exp_f32 v61, v61
    v_exp_f32 v62, v62
    v_exp_f32 v63, v63
    v_cvt_pk_bf16_f32 v88, v60, v61
    v_mfma_f32_32x32x16_bf16 v[20:35], v[116:119], v[84:87], v[20:35]
    v_exp_f32 v64, v64
    v_cvt_pk_bf16_f32 v89, v62, v63
    v_exp_f32 v65, v65
    v_exp_f32 v66, v66
    v_exp_f32 v67, v67
    v_cvt_pk_bf16_f32 v90, v64, v65
    v_cvt_pk_bf16_f32 v91, v66, v67
    s_waitcnt lgkmcnt(0)
    v_mfma_f32_32x32x16_bf16 v[52:67], v[92:95], v[4:7], 0
    v_exp_f32 v68, v68
    v_exp_f32 v69, v69
    v_exp_f32 v70, v70
    v_exp_f32 v71, v71
    v_cvt_pk_bf16_f32 v84, v68, v69
    v_mfma_f32_32x32x16_bf16 v[20:35], v[120:123], v[88:91], v[20:35]
    v_exp_f32 v72, v72
    v_cvt_pk_bf16_f32 v85, v70, v71
    v_exp_f32 v73, v73
    v_exp_f32 v74, v74
    v_exp_f32 v75, v75
    v_cvt_pk_bf16_f32 v86, v72, v73
    v_mfma_f32_32x32x8_bf16 v[52:67], v[100:101], v[12:13], v[52:67]
    v_exp_f32 v76, v76
    v_cvt_pk_bf16_f32 v87, v74, v75
    v_exp_f32 v77, v77
    v_exp_f32 v78, v78
    v_exp_f32 v79, v79
    v_cvt_pk_bf16_f32 v88, v76, v77
    v_mfma_f32_32x32x16_bf16 v[36:51], v[116:119], v[84:87], v[36:51]
    v_exp_f32 v80, v80
    v_cvt_pk_bf16_f32 v89, v78, v79
    v_exp_f32 v81, v81
    v_exp_f32 v82, v82
    v_exp_f32 v83, v83
    v_cvt_pk_bf16_f32 v90, v80, v81
    v_cvt_pk_bf16_f32 v91, v82, v83
    s_add_u32 s42, s42, 1
    s_cmp_lt_u32 s42, 8
    s_cbranch_scc1 L2_loop1
    s_branch L2_tail
L2_pre:
    s_mov_b32 s44, 0
L_poll_kv:
    s_mov_b64 exec, 0xfffffff
    buffer_load_dword v251, v250, s[96:99], 0 offen sc1
    s_waitcnt vmcnt(0)
    v_cmp_ne_u32 vcc, s84, v251
    s_mov_b64 exec, -1
    s_add_u32 s44, s44, 1
    s_cbranch_vccz L_polldone_kv
    s_cmp_lt_u32 s44, 0x100000
    s_cbranch_scc0 L_polldone_kv
    s_branch L_poll_kv
L_polldone_kv:
    s_branch L2_preret
L2_secretx:
    s_cmp_eq_u32 s38, 0
    s_cbranch_scc1 L2_secret0
    s_branch L2_secret1
L2_payload:
    s_cmp_eq_u32 s42, 0
    s_cbranch_scc1 L2_sec0
    s_cmp_eq_u32 s42, 1
    s_cbranch_scc1 L2_sec1
    s_cmp_eq_u32 s42, 2
    s_cbranch_scc1 L2_sec2
    s_cmp_eq_u32 s42, 3
    s_cbranch_scc1 L2_sec3
    s_cmp_eq_u32 s42, 4
    s_cbranch_scc1 L2_sec4
    s_cmp_eq_u32 s42, 5
    s_cbranch_scc1 L2_sec5
    s_cmp_eq_u32 s42, 6
    s_cbranch_scc1 L2_sec6
    s_branch L2_sec7
L2_sec0:
    s_cmp_lt_u32 s3, 5
    s_cbranch_scc0 L2_nw_wr
    s_add_u32 s44, s30, 0
    s_cmp_ge_u32 s44, 160
    s_cselect_b32 s48, s76, s68
    s_cselect_b32 s49, s77, s69
    s_mov_b32 s50, 819200
    s_mov_b32 s51, 0x00020000
    s_lshl_b32 s45, s3, 10
    s_add_u32 m0, s45, 148480
    s_nop 0
    buffer_load_dwordx4 v248, s[48:51], 0 offen lds
    s_add_u32 s44, s30, 256
    s_cmp_ge_u32 s44, 160
    s_cselect_b32 s48, s76, s68
    s_cselect_b32 s49, s77, s69
    s_mov_b32 s50, 819200
    s_mov_b32 s51, 0x00020000
    s_lshl_b32 s45, s3, 10
    s_add_u32 m0, s45, 154624
    s_nop 0
    buffer_load_dwordx4 v249, s[48:51], 0 offen lds
L2_nw_wr:
    s_cmp_eq_u32 s38, 0
    s_cbranch_scc0 L2_np_b0
    v_mfma_f32_32x32x16_bf16 v[192:207], v[240:243], v[132:135], 0
    v_mfma_f32_32x32x16_bf16 v[192:207], v[244:247], v[136:139], v[192:207]
    s_nop 15
    v_exp_f32 v152, -v192
    v_exp_f32 v192, v192
    v_exp_f32 v153, -v193
    v_exp_f32 v193, v193
    v_exp_f32 v154, -v194
    v_exp_f32 v194, v194
    v_exp_f32 v155, -v195
    v_exp_f32 v195, v195
    v_exp_f32 v156, -v196
    v_exp_f32 v196, v196
    v_exp_f32 v157, -v197
    v_exp_f32 v197, v197
    v_exp_f32 v158, -v198
    v_exp_f32 v198, v198
    v_exp_f32 v159, -v199
    v_exp_f32 v199, v199
    v_exp_f32 v160, -v200
    v_exp_f32 v200, v200
    v_exp_f32 v161, -v201
    v_exp_f32 v201, v201
    v_pk_add_f32 v[168:169], v[152:153], v[154:155]
    v_pk_add_f32 v[166:167], v[192:193], v[194:195]
    v_pk_add_f32 v[168:169], v[168:169], v[156:157]
    v_pk_add_f32 v[166:167], v[166:167], v[196:197]
    v_pk_add_f32 v[168:169], v[168:169], v[158:159]
    v_pk_add_f32 v[166:167], v[166:167], v[198:199]
    v_pk_add_f32 v[168:169], v[168:169], v[160:161]
    v_pk_add_f32 v[166:167], v[166:167], v[200:201]
    v_add_f32 v162, v166, v167
    v_add_f32 v163, v168, v169
    s_nop 1
    v_permlane32_swap_b32 v162, v163
    s_nop 1
    v_add_f32 v162, v162, v163
    v_mov_b32 v164, v162
    s_nop 1
    v_permlane32_swap_b32 v162, v164
    s_nop 1
    v_min_f32 v163, v162, v164
    v_max_f32 v165, v162, v164
    v_add_f32 v165, v165, v163
    s_mov_b32 s44, 0x1f800000
    s_mov_b32 s45, 0x5f800000
    v_cmp_nle_f32 vcc, s44, v163
    v_cmp_nge_f32 s[46:47], s45, v165
    s_nop 1
    s_or_b64 vcc, vcc, s[46:47]
    s_cbranch_vccz L2_fm_ok_k0
    v_mfma_f32_32x32x16_bf16 v[192:207], v[240:243], v[132:135], 0
    v_mfma_f32_32x32x16_bf16 v[192:207], v[244:247], v[136:139], v[192:207]
    s_nop 15
    v_max3_f32 v162, v192, v193, v194
    v_min3_f32 v163, v192, v193, v194
    v_max3_f32 v162, v162, v195, v196
    v_min3_f32 v163, v163, v195, v196
    v_max3_f32 v162, v162, v197, v198
    v_min3_f32 v163, v163, v197, v198
    v_max3_f32 v162, v162, v199, v200
    v_min3_f32 v163, v163, v199, v200
    v_max_f32 v162, v162, v201
    v_min_f32 v163, v163, v201
    v_mov_b32 v164, v162
    v_mov_b32 v165, v163
    s_nop 1
    v_permlane32_swap_b32 v162, v164
    v_permlane32_swap_b32 v163, v165
    s_nop 1
    v_max_f32 v164, v162, v164
    v_min_f32 v165, v163, v165
    v_sub_f32 v152, v165, v192
    v_sub_f32 v192, v192, v164
    v_sub_f32 v153, v165, v193
    v_sub_f32 v193, v193, v164
    v_sub_f32 v154, v165, v194
    v_sub_f32 v194, v194, v164
    v_sub_f32 v155, v165, v195
    v_sub_f32 v195, v195, v164
    v_sub_f32 v156, v165, v196
    v_sub_f32 v196, v196, v164
    v_sub_f32 v157, v165, v197
    v_sub_f32 v197, v197, v164
    v_sub_f32 v158, v165, v198
    v_sub_f32 v198, v198, v164
    v_sub_f32 v159, v165, v199
    v_sub_f32 v199, v199, v164
    v_sub_f32 v160, v165, v200
    v_sub_f32 v200, v200, v164
    v_sub_f32 v161, v165, v201
    v_sub_f32 v201, v201, v164
    v_exp_f32 v192, v192
    v_exp_f32 v152, v152
    v_exp_f32 v193, v193
    v_exp_f32 v153, v153
    v_exp_f32 v194, v194
    v_exp_f32 v154, v154
    v_exp_f32 v195, v195
    v_exp_f32 v155, v155
    v_exp_f32 v196, v196
    v_exp_f32 v156, v156
    v_exp_f32 v197, v197
    v_exp_f32 v157, v157
    v_exp_f32 v198, v198
    v_exp_f32 v158, v158
    v_exp_f32 v199, v199
    v_exp_f32 v159, v159
    v_exp_f32 v200, v200
    v_exp_f32 v160, v160
    v_exp_f32 v201, v201
    v_exp_f32 v161, v161
    s_nop 0
    v_pk_add_f32 v[168:169], v[152:153], v[154:155]
    v_pk_add_f32 v[166:167], v[192:193], v[194:195]
    v_pk_add_f32 v[168:169], v[168:169], v[156:157]
    v_pk_add_f32 v[166:167], v[166:167], v[196:197]
    v_pk_add_f32 v[168:169], v[168:169], v[158:159]
    v_pk_add_f32 v[166:167], v[166:167], v[198:199]
    v_pk_add_f32 v[168:169], v[168:169], v[160:161]
    v_pk_add_f32 v[166:167], v[166:167], v[200:201]
    v_add_f32 v162, v166, v167
    v_add_f32 v163, v168, v169
    s_nop 1
    v_permlane32_swap_b32 v162, v163
    s_nop 1
    v_add_f32 v162, v162, v163
    v_mov_b32 v164, v162
    s_nop 1
    v_permlane32_swap_b32 v162, v164
    s_nop 1
L2_fm_ok_k0:
    v_rcp_f32 v162, v162
    v_rcp_f32 v164, v164
    s_nop 0
    v_pk_mul_f32 v[192:193], v[192:193], v[162:163] op_sel_hi:[1,0]
    v_pk_mul_f32 v[152:153], v[152:153], v[164:165] op_sel_hi:[1,0]
    v_pk_mul_f32 v[194:195], v[194:195], v[162:163] op_sel_hi:[1,0]
    v_pk_mul_f32 v[154:155], v[154:155], v[164:165] op_sel_hi:[1,0]
    v_pk_mul_f32 v[196:197], v[196:197], v[162:163] op_sel_hi:[1,0]
    v_pk_mul_f32 v[156:157], v[156:157], v[164:165] op_sel_hi:[1,0]
    v_pk_mul_f32 v[198:199], v[198:199], v[162:163] op_sel_hi:[1,0]
    v_pk_mul_f32 v[158:159], v[158:159], v[164:165] op_sel_hi:[1,0]
    v_pk_mul_f32 v[200:201], v[200:201], v[162:163] op_sel_hi:[1,0]
    v_pk_mul_f32 v[160:161], v[160:161], v[164:165] op_sel_hi:[1,0]
    v_cvt_pk_bf16_f32 v140, v192, v193
    v_cvt_pk_bf16_f32 v145, v152, v153
    v_cvt_pk_bf16_f32 v141, v194, v195
    v_cvt_pk_bf16_f32 v146, v154, v155
    v_cvt_pk_bf16_f32 v142, v196, v197
    v_cvt_pk_bf16_f32 v147, v156, v157
    v_cvt_pk_bf16_f32 v143, v198, v199
    v_cvt_pk_bf16_f32 v148, v158, v159
    v_cvt_pk_bf16_f32 v144, v200, v201
    v_cvt_pk_bf16_f32 v149, v160, v161
    ds_write_b64 v233, v[140:141] offset:0
    ds_write_b64 v233, v[142:143] offset:8
    ds_write_b64 v233, v[144:145] offset:16
    ds_write_b64 v233, v[146:147] offset:24
    ds_write_b64 v233, v[148:149] offset:32
    s_waitcnt lgkmcnt(0)
    ds_read_b64_tr_b16 v[208:209], v234 offset:0
    ds_read_b64_tr_b16 v[210:211], v234 offset:320
    ds_read_b64_tr_b16 v[212:213], v234 offset:1280
    ds_read_b64_tr_b16 v[214:215], v234 offset:1600
    ds_read_b64_tr_b16 v[216:217], v234 offset:32
    ds_read_b64_tr_b16 v[218:219], v234 offset:352
    ds_read_b64_tr_b16 v[220:221], v234 offset:1312
    ds_read_b64_tr_b16 v[222:223], v234 offset:1632
    ds_read_b64_tr_b16 v[224:225], v232 offset:0
    ds_read_b64_tr_b16 v[226:227], v232 offset:64
    ds_read_b64_tr_b16 v[228:229], v232 offset:256
    ds_read_b64_tr_b16 v[230:231], v232 offset:320
    s_waitcnt lgkmcnt(0)
    v_mfma_f32_32x32x16_bf16 v[192:207], v[208:211], v[224:227], 0
    v_mfma_f32_32x32x16_bf16 v[152:167], v[216:219], v[224:227], 0
    v_mfma_f32_32x32x16_bf16 v[192:207], v[212:215], v[228:231], v[192:207]
    v_mfma_f32_32x32x16_bf16 v[152:167], v[220:223], v[228:231], v[152:167]
    v_and_b32 v1, 31, v0
    v_lshrrev_b32 v2, 5, v0
    v_mul_u32_u24 v2, 24, v2
    v_add_u32 v2, v2, v1
    s_lshl_b32 s46, s3, 12
    s_add_u32 s46, s46, 99328
    v_lshlrev_b32 v2, 4, v2
    v_add_u32 v2, s46, v2
    v_cmp_gt_u32 vcc, 24, v1
    s_nop 12
    s_and_saveexec_b64 s[46:47], vcc
    ds_write_b128 v2, v[192:195] offset:0
    ds_write_b128 v2, v[196:199] offset:768
    ds_write_b128 v2, v[200:203] offset:1536
    ds_write_b128 v2, v[204:207] offset:2304
    ds_write_b128 v2, v[152:155] offset:3072
    s_mov_b64 exec, s[46:47]
    s_waitcnt lgkmcnt(0)
    s_add_u32 s45, s85, 128
    s_mul_i32 s45, s45, 98304
    buffer_load_dwordx4 v[132:135], v236, s[16:19], s45 offen offset:512 sc1
    s_mov_b32 exec_hi, 0
    buffer_load_dwordx4 v[136:139], v237, s[16:19], s45 offen offset:512 sc1
    s_mov_b64 exec, -1
L2_np_b0:
    s_branch L2_secretx
L2_sec1:
    s_cmp_lt_u32 s3, 4
    s_cbranch_scc0 L2_nw_wt
    v_lshrrev_b32 v1, 4, v0
    v_bfe_u32 v2, v0, 2, 2
    v_lshl_add_u32 v1, v1, 3, v2
    v_mul_u32_u24 v1, 160, v1
    v_and_b32 v2, 3, v0
    v_lshl_add_u32 v1, v2, 3, v1
    s_lshl_b32 s45, s3, 5
    s_add_u32 s45, s45, 148480
    v_add_u32 v1, s45, v1
    ds_read_b64_tr_b16 v[192:193], v1 offset:0
    ds_read_b64_tr_b16 v[194:195], v1 offset:640
    ds_read_b64_tr_b16 v[196:197], v1 offset:6144
    ds_read_b64_tr_b16 v[198:199], v1 offset:6784
    s_waitcnt lgkmcnt(0)
    s_add_u32 s44, s30, 0
    s_mul_i32 s44, s44, 5120
    s_lshl_b32 s45, s3, 10
    s_add_u32 s44, s44, s45
    buffer_store_dwordx4 v[192:195], v130, s[24:27], s44 offen sc1
    s_add_u32 s44, s30, 256
    s_mul_i32 s44, s44, 5120
    s_lshl_b32 s45, s3, 10
    s_add_u32 s44, s44, s45
    buffer_store_dwordx4 v[196:199], v130, s[24:27], s44 offen sc1
L2_nw_wt:
    s_cmp_lt_u32 s3, 1
    s_cbranch_scc0 L2_nw_wt4
    v_lshrrev_b32 v1, 4, v0
    v_bfe_u32 v2, v0, 2, 2
    v_lshl_add_u32 v1, v1, 3, v2
    v_mul_u32_u24 v1, 160, v1
    v_and_b32 v2, 3, v0
    v_lshl_add_u32 v1, v2, 3, v1
    s_lshl_b32 s45, 4, 5
    s_add_u32 s45, s45, 148480
    v_add_u32 v1, s45, v1
    ds_read_b64_tr_b16 v[192:193], v1 offset:0
    ds_read_b64_tr_b16 v[194:195], v1 offset:640
    ds_read_b64_tr_b16 v[196:197], v1 offset:6144
    ds_read_b64_tr_b16 v[198:199], v1 offset:6784
    s_waitcnt lgkmcnt(0)
    s_add_u32 s44, s30, 0
    s_mul_i32 s44, s44, 5120
    s_lshl_b32 s45, 4, 10
    s_add_u32 s44, s44, s45
    buffer_store_dwordx4 v[192:195], v130, s[24:27], s44 offen sc1
    s_add_u32 s44, s30, 256
    s_mul_i32 s44, s44, 5120
    s_lshl_b32 s45, 4, 10
    s_add_u32 s44, s44, s45
    buffer_store_dwordx4 v[196:199], v130, s[24:27], s44 offen sc1
L2_nw_wt4:
    s_cmp_eq_u32 s38, 0
    s_cbranch_scc0 L2_np_b1
    v_mfma_f32_32x32x16_bf16 v[192:207], v[240:243], v[132:135], 0
    v_mfma_f32_32x32x16_bf16 v[192:207], v[244:247], v[136:139], v[192:207]
    s_nop 15
    v_exp_f32 v152, -v192
    v_exp_f32 v192, v192
    v_exp_f32 v153, -v193
    v_exp_f32 v193, v193
    v_exp_f32 v154, -v194
    v_exp_f32 v194, v194
    v_exp_f32 v155, -v195
    v_exp_f32 v195, v195
    v_exp_f32 v156, -v196
    v_exp_f32 v196, v196
    v_exp_f32 v157, -v197
    v_exp_f32 v197, v197
    v_exp_f32 v158, -v198
    v_exp_f32 v198, v198
    v_exp_f32 v159, -v199
    v_exp_f32 v199, v199
    v_exp_f32 v160, -v200
    v_exp_f32 v200, v200
    v_exp_f32 v161, -v201
    v_exp_f32 v201, v201
    v_pk_add_f32 v[168:169], v[152:153], v[154:155]
    v_pk_add_f32 v[166:167], v[192:193], v[194:195]
    v_pk_add_f32 v[168:169], v[168:169], v[156:157]
    v_pk_add_f32 v[166:167], v[166:167], v[196:197]
    v_pk_add_f32 v[168:169], v[168:169], v[158:159]
    v_pk_add_f32 v[166:167], v[166:167], v[198:199]
    v_pk_add_f32 v[168:169], v[168:169], v[160:161]
    v_pk_add_f32 v[166:167], v[166:167], v[200:201]
    v_add_f32 v162, v166, v167
    v_add_f32 v163, v168, v169
    s_nop 1
    v_permlane32_swap_b32 v162, v163
    s_nop 1
    v_add_f32 v162, v162, v163
    v_mov_b32 v164, v162
    s_nop 1
    v_permlane32_swap_b32 v162, v164
    s_nop 1
    v_min_f32 v163, v162, v164
    v_max_f32 v165, v162, v164
    v_add_f32 v165, v165, v163
    s_mov_b32 s44, 0x1f800000
    s_mov_b32 s45, 0x5f800000
    v_cmp_nle_f32 vcc, s44, v163
    v_cmp_nge_f32 s[46:47], s45, v165
    s_nop 1
    s_or_b64 vcc, vcc, s[46:47]
    s_cbranch_vccz L2_fm_ok_k1
    v_mfma_f32_32x32x16_bf16 v[192:207], v[240:243], v[132:135], 0
    v_mfma_f32_32x32x16_bf16 v[192:207], v[244:247], v[136:139], v[192:207]
    s_nop 15
    v_max3_f32 v162, v192, v193, v194
    v_min3_f32 v163, v192, v193, v194
    v_max3_f32 v162, v162, v195, v196
    v_min3_f32 v163, v163, v195, v196
    v_max3_f32 v162, v162, v197, v198
    v_min3_f32 v163, v163, v197, v198
    v_max3_f32 v162, v162, v199, v200
    v_min3_f32 v163, v163, v199, v200
    v_max_f32 v162, v162, v201
    v_min_f32 v163, v163, v201
    v_mov_b32 v164, v162
    v_mov_b32 v165, v163
    s_nop 1
    v_permlane32_swap_b32 v162, v164
    v_permlane32_swap_b32 v163, v165
    s_nop 1
    v_max_f32 v164, v162, v164
    v_min_f32 v165, v163, v165
    v_sub_f32 v152, v165, v192
    v_sub_f32 v192, v192, v164
    v_sub_f32 v153, v165, v193
    v_sub_f32 v193, v193, v164
    v_sub_f32 v154, v165, v194
    v_sub_f32 v194, v194, v164
    v_sub_f32 v155, v165, v195
    v_sub_f32 v195, v195, v164
    v_sub_f32 v156, v165, v196
    v_sub_f32 v196, v196, v164
    v_sub_f32 v157, v165, v197
    v_sub_f32 v197, v197, v164
    v_sub_f32 v158, v165, v198
    v_sub_f32 v198, v198, v164
    v_sub_f32 v159, v165, v199
    v_sub_f32 v199, v199, v164
    v_sub_f32 v160, v165, v200
    v_sub_f32 v200, v200, v164
    v_sub_f32 v161, v165, v201
    v_sub_f32 v201, v201, v164
    v_exp_f32 v192, v192
    v_exp_f32 v152, v152
    v_exp_f32 v193, v193
    v_exp_f32 v153, v153
    v_exp_f32 v194, v194
    v_exp_f32 v154, v154
    v_exp_f32 v195, v195
    v_exp_f32 v155, v155
    v_exp_f32 v196, v196
    v_exp_f32 v156, v156
    v_exp_f32 v197, v197
    v_exp_f32 v157, v157
    v_exp_f32 v198, v198
    v_exp_f32 v158, v158
    v_exp_f32 v199, v199
    v_exp_f32 v159, v159
    v_exp_f32 v200, v200
    v_exp_f32 v160, v160
    v_exp_f32 v201, v201
    v_exp_f32 v161, v161
    s_nop 0
    v_pk_add_f32 v[168:169], v[152:153], v[154:155]
    v_pk_add_f32 v[166:167], v[192:193], v[194:195]
    v_pk_add_f32 v[168:169], v[168:169], v[156:157]
    v_pk_add_f32 v[166:167], v[166:167], v[196:197]
    v_pk_add_f32 v[168:169], v[168:169], v[158:159]
    v_pk_add_f32 v[166:167], v[166:167], v[198:199]
    v_pk_add_f32 v[168:169], v[168:169], v[160:161]
    v_pk_add_f32 v[166:167], v[166:167], v[200:201]
    v_add_f32 v162, v166, v167
    v_add_f32 v163, v168, v169
    s_nop 1
    v_permlane32_swap_b32 v162, v163
    s_nop 1
    v_add_f32 v162, v162, v163
    v_mov_b32 v164, v162
    s_nop 1
    v_permlane32_swap_b32 v162, v164
    s_nop 1
L2_fm_ok_k1:
    v_rcp_f32 v162, v162
    v_rcp_f32 v164, v164
    s_nop 0
    v_pk_mul_f32 v[192:193], v[192:193], v[162:163] op_sel_hi:[1,0]
    v_pk_mul_f32 v[152:153], v[152:153], v[164:165] op_sel_hi:[1,0]
    v_pk_mul_f32 v[194:195], v[194:195], v[162:163] op_sel_hi:[1,0]
    v_pk_mul_f32 v[154:155], v[154:155], v[164:165] op_sel_hi:[1,0]
    v_pk_mul_f32 v[196:197], v[196:197], v[162:163] op_sel_hi:[1,0]
    v_pk_mul_f32 v[156:157], v[156:157], v[164:165] op_sel_hi:[1,0]
    v_pk_mul_f32 v[198:199], v[198:199], v[162:163] op_sel_hi:[1,0]
    v_pk_mul_f32 v[158:159], v[158:159], v[164:165] op_sel_hi:[1,0]
    v_pk_mul_f32 v[200:201], v[200:201], v[162:163] op_sel_hi:[1,0]
    v_pk_mul_f32 v[160:161], v[160:161], v[164:165] op_sel_hi:[1,0]
    v_cvt_pk_bf16_f32 v140, v192, v193
    v_cvt_pk_bf16_f32 v145, v152, v153
    v_cvt_pk_bf16_f32 v141, v194, v195
    v_cvt_pk_bf16_f32 v146, v154, v155
    v_cvt_pk_bf16_f32 v142, v196, v197
    v_cvt_pk_bf16_f32 v147, v156, v157
    v_cvt_pk_bf16_f32 v143, v198, v199
    v_cvt_pk_bf16_f32 v148, v158, v159
    v_cvt_pk_bf16_f32 v144, v200, v201
    v_cvt_pk_bf16_f32 v149, v160, v161
    ds_write_b64 v233, v[140:141] offset:16384
    ds_write_b64 v233, v[142:143] offset:16392
    ds_write_b64 v233, v[144:145] offset:16400
    ds_write_b64 v233, v[146:147] offset:16408
    ds_write_b64 v233, v[148:149] offset:16416
    s_waitcnt lgkmcnt(0)
    ds_read_b64_tr_b16 v[208:209], v234 offset:16384
    ds_read_b64_tr_b16 v[210:211], v234 offset:16704
    ds_read_b64_tr_b16 v[212:213], v234 offset:17664
    ds_read_b64_tr_b16 v[214:215], v234 offset:17984
    ds_read_b64_tr_b16 v[216:217], v234 offset:16416
    ds_read_b64_tr_b16 v[218:219], v234 offset:16736
    ds_read_b64_tr_b16 v[220:221], v234 offset:17696
    ds_read_b64_tr_b16 v[222:223], v234 offset:18016
    ds_read_b64_tr_b16 v[224:225], v232 offset:16384
    ds_read_b64_tr_b16 v[226:227], v232 offset:16448
    ds_read_b64_tr_b16 v[228:229], v232 offset:16640
    ds_read_b64_tr_b16 v[230:231], v232 offset:16704
    s_waitcnt lgkmcnt(0)
    v_mfma_f32_32x32x16_bf16 v[192:207], v[208:211], v[224:227], 0
    v_mfma_f32_32x32x16_bf16 v[152:167], v[216:219], v[224:227], 0
    v_mfma_f32_32x32x16_bf16 v[192:207], v[212:215], v[228:231], v[192:207]
    v_mfma_f32_32x32x16_bf16 v[152:167], v[220:223], v[228:231], v[152:167]
    v_and_b32 v1, 31, v0
    v_lshrrev_b32 v2, 5, v0
    v_mul_u32_u24 v2, 24, v2
    v_add_u32 v2, v2, v1
    s_lshl_b32 s46, s3, 12
    s_add_u32 s46, s46, 115712
    v_lshlrev_b32 v2, 4, v2
    v_add_u32 v2, s46, v2
    v_cmp_gt_u32 vcc, 24, v1
    s_nop 12
    s_and_saveexec_b64 s[46:47], vcc
    ds_write_b128 v2, v[192:195] offset:0
    ds_write_b128 v2, v[196:199] offset:768
    ds_write_b128 v2, v[200:203] offset:1536
    ds_write_b128 v2, v[204:207] offset:2304
    ds_write_b128 v2, v[152:155] offset:3072
    s_mov_b64 exec, s[46:47]
    s_waitcnt lgkmcnt(0)
    s_add_u32 s45, s85, 96
    s_mul_i32 s45, s45, 98304
    buffer_load_dwordx4 v[132:135], v236, s[16:19], s45 offen offset:512 sc1
    s_mov_b32 exec_hi, 0
    buffer_load_dwordx4 v[136:139], v237, s[16:19], s45 offen offset:512 sc1
    s_mov_b64 exec, -1
L2_np_b1:
    s_branch L2_secretx
L2_sec2:
    s_cmp_lt_u32 s3, 4
    s_cbranch_scc0 L2_nw_rd
    s_mul_i32 s46, s3, 768
    s_add_u32 s46, s46, 99328
    v_add_u32 v2, s46, v130
    s_mov_b32 exec_lo, -1
    s_mov_b32 exec_hi, 0xffff
    ds_read_b128 v[192:195], v2 offset:0
    ds_read_b128 v[196:199], v2 offset:4096
    ds_read_b128 v[200:203], v2 offset:8192
    ds_read_b128 v[204:207], v2 offset:12288
    ds_read_b128 v[208:211], v2 offset:16384
    ds_read_b128 v[212:215], v2 offset:20480
    ds_read_b128 v[216:219], v2 offset:24576
    ds_read_b128 v[220:223], v2 offset:28672
    s_waitcnt lgkmcnt(0)
    v_pk_add_f32 v[192:193], v[192:193], v[196:197]
    v_pk_add_f32 v[194:195], v[194:195], v[198:199]
    v_pk_add_f32 v[192:193], v[192:193], v[200:201]
    v_pk_add_f32 v[194:195], v[194:195], v[202:203]
    v_pk_add_f32 v[192:193], v[192:193], v[204:205]
    v_pk_add_f32 v[194:195], v[194:195], v[206:207]
    v_pk_add_f32 v[192:193], v[192:193], v[208:209]
    v_pk_add_f32 v[194:195], v[194:195], v[210:211]
    v_pk_add_f32 v[192:193], v[192:193], v[212:213]
    v_pk_add_f32 v[194:195], v[194:195], v[214:215]
    v_pk_add_f32 v[192:193], v[192:193], v[216:217]
    v_pk_add_f32 v[194:195], v[194:195], v[218:219]
    v_pk_add_f32 v[192:193], v[192:193], v[220:221]
    v_pk_add_f32 v[194:195], v[194:195], v[222:223]
    s_mul_i32 s46, s30, 5120
    s_mul_i32 s47, s3, 768
    s_add_u32 s46, s46, s47
    buffer_store_dwordx4 v[192:195], v130, s[12:15], s46 offen sc1
    s_mov_b64 exec, -1
    s_nop 1
L2_nw_rd:
    s_cmp_lt_u32 s3, 1
    s_cbranch_scc0 L2_nw_rd4
    s_mul_i32 s46, 4, 768
    s_add_u32 s46, s46, 99328
    v_add_u32 v2, s46, v130
    s_mov_b32 exec_lo, -1
    s_mov_b32 exec_hi, 0xffff
    ds_read_b128 v[192:195], v2 offset:0
    ds_read_b128 v[196:199], v2 offset:4096
    ds_read_b128 v[200:203], v2 offset:8192
    ds_read_b128 v[204:207], v2 offset:12288
    ds_read_b128 v[208:211], v2 offset:16384
    ds_read_b128 v[212:215], v2 offset:20480
    ds_read_b128 v[216:219], v2 offset:24576
    ds_read_b128 v[220:223], v2 offset:28672
    s_waitcnt lgkmcnt(0)
    v_pk_add_f32 v[192:193], v[192:193], v[196:197]
    v_pk_add_f32 v[194:195], v[194:195], v[198:199]
    v_pk_add_f32 v[192:193], v[192:193], v[200:201]
    v_pk_add_f32 v[194:195], v[194:195], v[202:203]
    v_pk_add_f32 v[192:193], v[192:193], v[204:205]
    v_pk_add_f32 v[194:195], v[194:195], v[206:207]
    v_pk_add_f32 v[192:193], v[192:193], v[208:209]
    v_pk_add_f32 v[194:195], v[194:195], v[210:211]
    v_pk_add_f32 v[192:193], v[192:193], v[212:213]
    v_pk_add_f32 v[194:195], v[194:195], v[214:215]
    v_pk_add_f32 v[192:193], v[192:193], v[216:217]
    v_pk_add_f32 v[194:195], v[194:195], v[218:219]
    v_pk_add_f32 v[192:193], v[192:193], v[220:221]
    v_pk_add_f32 v[194:195], v[194:195], v[222:223]
    s_mul_i32 s46, s30, 5120
    s_mul_i32 s47, 4, 768
    s_add_u32 s46, s46, s47
    buffer_store_dwordx4 v[192:195], v130, s[12:15], s46 offen sc1
    s_mov_b64 exec, -1
    s_nop 1
L2_nw_rd4:
    s_branch L2_secretx
L2_sec3:
    s_cmp_lt_u32 s3, 1
    s_cbranch_scc0 L2_nw_f2
    s_lshl_b32 s44, s30, 7
    s_add_u32 s44, s44, 65536
    v_mov_b32 v152, s44
    v_mov_b32 v153, s84
    s_mov_b64 exec, 1
    buffer_store_dword v153, v152, s[96:99], 0 offen sc1
    s_mov_b64 exec, -1
L2_nw_f2:
    s_branch L2_secretx
L2_sec4:
    s_cmp_lt_u32 s3, 4
    s_cbranch_scc0 L2_nw_ga
    s_mul_i32 s46, s85, 40960
    s_mul_i32 s47, s3, 768
    s_add_u32 s46, s46, s47
    s_mov_b32 exec_lo, -1
    s_mov_b32 exec_hi, 0xffff
    buffer_load_dwordx4 v[192:195], v130, s[12:15], s46 offen sc1
    s_add_u32 s46, s46, 5120
    buffer_load_dwordx4 v[196:199], v130, s[12:15], s46 offen sc1
    s_add_u32 s46, s46, 5120
    buffer_load_dwordx4 v[200:203], v130, s[12:15], s46 offen sc1
    s_add_u32 s46, s46, 5120
    buffer_load_dwordx4 v[204:207], v130, s[12:15], s46 offen sc1
    s_add_u32 s46, s46, 5120
    buffer_load_dwordx4 v[208:211], v130, s[12:15], s46 offen sc1
    s_add_u32 s46, s46, 5120
    buffer_load_dwordx4 v[212:215], v130, s[12:15], s46 offen sc1
    s_add_u32 s46, s46, 5120
    buffer_load_dwordx4 v[216:219], v130, s[12:15], s46 offen sc1
    s_add_u32 s46, s46, 5120
    buffer_load_dwordx4 v[220:223], v130, s[12:15], s46 offen sc1
    s_add_u32 s46, s46, 5120
    s_mov_b64 exec, -1
L2_nw_ga:
    s_cmp_lt_u32 s3, 1
    s_cbranch_scc0 L2_nw_ga4
    s_mul_i32 s46, s85, 40960
    s_mul_i32 s47, 4, 768
    s_add_u32 s46, s46, s47
    s_mov_b32 exec_lo, -1
    s_mov_b32 exec_hi, 0xffff
    buffer_load_dwordx4 v[152:155], v130, s[12:15], s46 offen sc1
    s_add_u32 s46, s46, 5120
    buffer_load_dwordx4 v[156:159], v130, s[12:15], s46 offen sc1
    s_add_u32 s46, s46, 5120
    buffer_load_dwordx4 v[160:163], v130, s[12:15], s46 offen sc1
    s_add_u32 s46, s46, 5120
    buffer_load_dwordx4 v[164:167], v130, s[12:15], s46 offen sc1
    s_add_u32 s46, s46, 5120
    buffer_load_dwordx4 v[168:171], v130, s[12:15], s46 offen sc1
    s_add_u32 s46, s46, 5120
    buffer_load_dwordx4 v[172:175], v130, s[12:15], s46 offen sc1
    s_add_u32 s46, s46, 5120
    buffer_load_dwordx4 v[176:179], v130, s[12:15], s46 offen sc1
    s_add_u32 s46, s46, 5120
    buffer_load_dwordx4 v[180:183], v130, s[12:15], s46 offen sc1
    s_add_u32 s46, s46, 5120
    s_mov_b64 exec, -1
L2_nw_ga4:
    s_cmp_eq_u32 s38, 0
    s_cbranch_scc0 L2_np_wtch
    s_lshl_b32 s44, s56, 3
    s_add_u32 s44, s44, s58
    s_mul_i32 s44, s44, 102400
    s_and_b32 s45, s57, 3
    s_mul_i32 s45, s45, 25600
    s_add_u32 s44, s44, s45
    s_mul_i32 s45, s39, 6400
    s_add_u32 s44, s44, s45
    v_lshlrev_b32 v2, 7, v0
    s_mov_b32 exec_hi, 0x3ffff
    buffer_load_dword v253, v2, s[24:27], s44 offen sc1
    s_mov_b64 exec, -1
L2_np_wtch:
    s_branch L2_secretx
L2_sec5:
    s_cmp_lt_u32 s3, 4
    s_cbranch_scc0 L2_nw_tb
    s_mov_b32 exec_lo, -1
    s_mov_b32 exec_hi, 0xffff
    v_pk_add_f32 v[192:193], v[192:193], v[196:197]
    v_pk_add_f32 v[194:195], v[194:195], v[198:199]
    v_pk_add_f32 v[192:193], v[192:193], v[200:201]
    v_pk_add_f32 v[194:195], v[194:195], v[202:203]
    v_pk_add_f32 v[192:193], v[192:193], v[204:205]
    v_pk_add_f32 v[194:195], v[194:195], v[206:207]
    v_pk_add_f32 v[192:193], v[192:193], v[208:209]
    v_pk_add_f32 v[194:195], v[194:195], v[210:211]
    v_pk_add_f32 v[192:193], v[192:193], v[212:213]
    v_pk_add_f32 v[194:195], v[194:195], v[214:215]
    v_pk_add_f32 v[192:193], v[192:193], v[216:217]
    v_pk_add_f32 v[194:195], v[194:195], v[218:219]
    v_pk_add_f32 v[192:193], v[192:193], v[220:221]
    v_pk_add_f32 v[194:195], v[194:195], v[222:223]
    v_cvt_pk_bf16_f32 v224, v192, v193
    v_cvt_pk_bf16_f32 v225, v194, v195
    v_cmp_le_u32 vcc, 24, v0
    v_add_u32 v2, 8, v0
    s_nop 0
    v_cndmask_b32 v2, v0, v2, vcc
    v_mul_u32_u24 v2, 48, v2
    s_lshl_b32 s46, s3, 3
    s_add_u32 s46, s46, 160768
    v_add_u32 v2, s46, v2
    ds_write_b64 v2, v[224:225]
    s_mov_b64 exec, -1
    s_waitcnt lgkmcnt(0)
L2_nw_tb:
    s_cmp_lt_u32 s3, 1
    s_cbranch_scc0 L2_nw_tb4
    s_mov_b32 exec_lo, -1
    s_mov_b32 exec_hi, 0xffff
    v_pk_add_f32 v[152:153], v[152:153], v[156:157]
    v_pk_add_f32 v[154:155], v[154:155], v[158:159]
    v_pk_add_f32 v[152:153], v[152:153], v[160:161]
    v_pk_add_f32 v[154:155], v[154:155], v[162:163]
    v_pk_add_f32 v[152:153], v[152:153], v[164:165]
    v_pk_add_f32 v[154:155], v[154:155], v[166:167]
    v_pk_add_f32 v[152:153], v[152:153], v[168:169]
    v_pk_add_f32 v[154:155], v[154:155], v[170:171]
    v_pk_add_f32 v[152:153], v[152:153], v[172:173]
    v_pk_add_f32 v[154:155], v[154:155], v[174:175]
    v_pk_add_f32 v[152:153], v[152:153], v[176:177]
    v_pk_add_f32 v[154:155], v[154:155], v[178:179]
    v_pk_add_f32 v[152:153], v[152:153], v[180:181]
    v_pk_add_f32 v[154:155], v[154:155], v[182:183]
    v_cvt_pk_bf16_f32 v224, v152, v153
    v_cvt_pk_bf16_f32 v225, v154, v155
    v_cmp_le_u32 vcc, 24, v0
    v_add_u32 v2, 8, v0
    s_nop 0
    v_cndmask_b32 v2, v0, v2, vcc
    v_mul_u32_u24 v2, 48, v2
    s_lshl_b32 s46, 4, 3
    s_add_u32 s46, s46, 160768
    v_add_u32 v2, s46, v2
    ds_write_b64 v2, v[224:225]
    s_mov_b64 exec, -1
    s_waitcnt lgkmcnt(0)
L2_nw_tb4:
    s_cmp_eq_u32 s3, 1
    s_cbranch_scc0 L2_nopad
    s_mov_b32 exec_lo, -1
    s_mov_b32 exec_hi, 0xffff
    v_mov_b32 v224, 0
    v_mov_b32 v225, 0
    v_cmp_le_u32 vcc, 24, v0
    v_add_u32 v2, 8, v0
    s_nop 0
    v_cndmask_b32 v2, v0, v2, vcc
    v_mul_u32_u24 v2, 48, v2
    s_lshl_b32 s46, 5, 3
    s_add_u32 s46, s46, 160768
    v_add_u32 v2, s46, v2
    ds_write_b64 v2, v[224:225]
    s_mov_b64 exec, -1
    s_waitcnt lgkmcnt(0)
L2_nopad:
    s_branch L2_secretx
L2_sec6:
    s_cmp_eq_u32 s38, 0
    s_cbranch_scc0 L2_np_fb0
    s_lshl_b32 s44, s56, 3
    s_add_u32 s44, s44, s58
    s_mul_i32 s44, s44, 102400
    s_sub_u32 s45, s3, 0
    s_lshl_b32 s45, s45, 10
    s_add_u32 s44, s44, s45
    s_add_u32 m0, s45, 0
    s_add_u32 s46, s44, 0
    buffer_load_dwordx4 v130, s[24:27], s46 offen sc1 lds
    s_add_u32 m0, s45, 4096
    s_add_u32 s46, s44, 4096
    buffer_load_dwordx4 v130, s[24:27], s46 offen sc1 lds
    s_add_u32 m0, s45, 8192
    s_add_u32 s46, s44, 8192
    buffer_load_dwordx4 v130, s[24:27], s46 offen sc1 lds
    s_add_u32 m0, s45, 12288
    s_add_u32 s46, s44, 12288
    buffer_load_dwordx4 v130, s[24:27], s46 offen sc1 lds
    s_add_u32 m0, s45, 16384
    s_add_u32 s46, s44, 16384
    buffer_load_dwordx4 v130, s[24:27], s46 offen sc1 lds
    s_add_u32 m0, s45, 20480
    s_add_u32 s46, s44, 20480
    buffer_load_dwordx4 v130, s[24:27], s46 offen sc1 lds
    s_add_u32 m0, s45, 24576
    s_add_u32 s46, s44, 24576
    buffer_load_dwordx4 v130, s[24:27], s46 offen sc1 lds
    s_add_u32 m0, s45, 28672
    s_add_u32 s46, s44, 28672
    buffer_load_dwordx4 v130, s[24:27], s46 offen sc1 lds
    s_add_u32 m0, s45, 32768
    s_add_u32 s46, s44, 32768
    buffer_load_dwordx4 v130, s[24:27], s46 offen sc1 lds
    s_add_u32 m0, s45, 36864
    s_add_u32 s46, s44, 36864
    buffer_load_dwordx4 v130, s[24:27], s46 offen sc1 lds
    s_add_u32 m0, s45, 40960
    s_add_u32 s46, s44, 40960
    buffer_load_dwordx4 v130, s[24:27], s46 offen sc1 lds
    s_add_u32 m0, s45, 45056
    s_add_u32 s46, s44, 45056
    buffer_load_dwordx4 v130, s[24:27], s46 offen sc1 lds
    v_mfma_f32_32x32x16_bf16 v[192:207], v[240:243], v[184:187], 0
    v_mfma_f32_32x32x16_bf16 v[192:207], v[244:247], v[188:191], v[192:207]
    s_nop 15
    v_exp_f32 v152, -v192
    v_exp_f32 v192, v192
    v_exp_f32 v153, -v193
    v_exp_f32 v193, v193
    v_exp_f32 v154, -v194
    v_exp_f32 v194, v194
    v_exp_f32 v155, -v195
    v_exp_f32 v195, v195
    v_exp_f32 v156, -v196
    v_exp_f32 v196, v196
    v_exp_f32 v157, -v197
    v_exp_f32 v197, v197
    v_exp_f32 v158, -v198
    v_exp_f32 v198, v198
    v_exp_f32 v159, -v199
    v_exp_f32 v199, v199
    v_exp_f32 v160, -v200
    v_exp_f32 v200, v200
    v_exp_f32 v161, -v201
    v_exp_f32 v201, v201
    v_pk_add_f32 v[168:169], v[152:153], v[154:155]
    v_pk_add_f32 v[166:167], v[192:193], v[194:195]
    v_pk_add_f32 v[168:169], v[168:169], v[156:157]
    v_pk_add_f32 v[166:167], v[166:167], v[196:197]
    v_pk_add_f32 v[168:169], v[168:169], v[158:159]
    v_pk_add_f32 v[166:167], v[166:167], v[198:199]
    v_pk_add_f32 v[168:169], v[168:169], v[160:161]
    v_pk_add_f32 v[166:167], v[166:167], v[200:201]
    v_add_f32 v162, v166, v167
    v_add_f32 v163, v168, v169
    s_nop 1
    v_permlane32_swap_b32 v162, v163
    s_nop 1
    v_add_f32 v162, v162, v163
    v_mov_b32 v164, v162
    s_nop 1
    v_permlane32_swap_b32 v162, v164
    s_nop 1
    v_min_f32 v163, v162, v164
    v_max_f32 v165, v162, v164
    v_add_f32 v165, v165, v163
    s_mov_b32 s44, 0x1f800000
    s_mov_b32 s45, 0x5f800000
    v_cmp_nle_f32 vcc, s44, v163
    v_cmp_nge_f32 s[46:47], s45, v165
    s_nop 1
    s_or_b64 vcc, vcc, s[46:47]
    s_cbranch_vccz L2_fm_ok_f0
    v_mfma_f32_32x32x16_bf16 v[192:207], v[240:243], v[184:187], 0
    v_mfma_f32_32x32x16_bf16 v[192:207], v[244:247], v[188:191], v[192:207]
    s_nop 15
    v_max3_f32 v162, v192, v193, v194
    v_min3_f32 v163, v192, v193, v194
    v_max3_f32 v162, v162, v195, v196
    v_min3_f32 v163, v163, v195, v196
    v_max3_f32 v162, v162, v197, v198
    v_min3_f32 v163, v163, v197, v198
    v_max3_f32 v162, v162, v199, v200
    v_min3_f32 v163, v163, v199, v200
    v_max_f32 v162, v162, v201
    v_min_f32 v163, v163, v201
    v_mov_b32 v164, v162
    v_mov_b32 v165, v163
    s_nop 1
    v_permlane32_swap_b32 v162, v164
    v_permlane32_swap_b32 v163, v165
    s_nop 1
    v_max_f32 v164, v162, v164
    v_min_f32 v165, v163, v165
    v_sub_f32 v152, v165, v192
    v_sub_f32 v192, v192, v164
    v_sub_f32 v153, v165, v193
    v_sub_f32 v193, v193, v164
    v_sub_f32 v154, v165, v194
    v_sub_f32 v194, v194, v164
    v_sub_f32 v155, v165, v195
    v_sub_f32 v195, v195, v164
    v_sub_f32 v156, v165, v196
    v_sub_f32 v196, v196, v164
    v_sub_f32 v157, v165, v197
    v_sub_f32 v197, v197, v164
    v_sub_f32 v158, v165, v198
    v_sub_f32 v198, v198, v164
    v_sub_f32 v159, v165, v199
    v_sub_f32 v199, v199, v164
    v_sub_f32 v160, v165, v200
    v_sub_f32 v200, v200, v164
    v_sub_f32 v161, v165, v201
    v_sub_f32 v201, v201, v164
    v_exp_f32 v192, v192
    v_exp_f32 v152, v152
    v_exp_f32 v193, v193
    v_exp_f32 v153, v153
    v_exp_f32 v194, v194
    v_exp_f32 v154, v154
    v_exp_f32 v195, v195
    v_exp_f32 v155, v155
    v_exp_f32 v196, v196
    v_exp_f32 v156, v156
    v_exp_f32 v197, v197
    v_exp_f32 v157, v157
    v_exp_f32 v198, v198
    v_exp_f32 v158, v158
    v_exp_f32 v199, v199
    v_exp_f32 v159, v159
    v_exp_f32 v200, v200
    v_exp_f32 v160, v160
    v_exp_f32 v201, v201
    v_exp_f32 v161, v161
    s_nop 0
    v_pk_add_f32 v[168:169], v[152:153], v[154:155]
    v_pk_add_f32 v[166:167], v[192:193], v[194:195]
    v_pk_add_f32 v[168:169], v[168:169], v[156:157]
    v_pk_add_f32 v[166:167], v[166:167], v[196:197]
    v_pk_add_f32 v[168:169], v[168:169], v[158:159]
    v_pk_add_f32 v[166:167], v[166:167], v[198:199]
    v_pk_add_f32 v[168:169], v[168:169], v[160:161]
    v_pk_add_f32 v[166:167], v[166:167], v[200:201]
    v_add_f32 v162, v166, v167
    v_add_f32 v163, v168, v169
    s_nop 1
    v_permlane32_swap_b32 v162, v163
    s_nop 1
    v_add_f32 v162, v162, v163
    v_mov_b32 v164, v162
    s_nop 1
    v_permlane32_swap_b32 v162, v164
    s_nop 1
L2_fm_ok_f0:
    v_rcp_f32 v162, v162
    v_rcp_f32 v164, v164
    s_nop 0
    v_pk_mul_f32 v[192:193], v[192:193], v[162:163] op_sel_hi:[1,0]
    v_pk_mul_f32 v[152:153], v[152:153], v[164:165] op_sel_hi:[1,0]
    v_pk_mul_f32 v[194:195], v[194:195], v[162:163] op_sel_hi:[1,0]
    v_pk_mul_f32 v[154:155], v[154:155], v[164:165] op_sel_hi:[1,0]
    v_pk_mul_f32 v[196:197], v[196:197], v[162:163] op_sel_hi:[1,0]
    v_pk_mul_f32 v[156:157], v[156:157], v[164:165] op_sel_hi:[1,0]
    v_pk_mul_f32 v[198:199], v[198:199], v[162:163] op_sel_hi:[1,0]
    v_pk_mul_f32 v[158:159], v[158:159], v[164:165] op_sel_hi:[1,0]
    v_pk_mul_f32 v[200:201], v[200:201], v[162:163] op_sel_hi:[1,0]
    v_pk_mul_f32 v[160:161], v[160:161], v[164:165] op_sel_hi:[1,0]
    v_cvt_pk_bf16_f32 v140, v192, v193
    v_cvt_pk_bf16_f32 v145, v152, v153
    v_cvt_pk_bf16_f32 v141, v194, v195
    v_cvt_pk_bf16_f32 v146, v154, v155
    v_cvt_pk_bf16_f32 v142, v196, v197
    v_cvt_pk_bf16_f32 v147, v156, v157
    v_cvt_pk_bf16_f32 v143, v198, v199
    v_cvt_pk_bf16_f32 v148, v158, v159
    v_cvt_pk_bf16_f32 v144, v200, v201
    v_cvt_pk_bf16_f32 v149, v160, v161
    v_mov_b32 v150, 0
    v_mov_b32 v151, 0
    v_mul_u32_u24 v2, 48, v0
    v_add_u32 v2, 160768, v2
    ds_read_b128 v[208:211], v2 offset:0
    ds_read_b128 v[212:215], v2 offset:16
    ds_read_b128 v[216:219], v2 offset:32
    s_waitcnt lgkmcnt(0)
    v_mfma_f32_32x32x16_bf16 v[192:207], v[208:211], v[140:143], 0
    v_mfma_f32_32x32x16_bf16 v[192:207], v[212:215], v[144:147], v[192:207]
    v_mfma_f32_32x32x16_bf16 v[192:207], v[216:219], v[148:151], v[192:207]
    s_nop 15
    v_mov_b32 v152, v200
    v_mov_b32 v154, v200
    s_mov_b32 s45, 2621440
    s_nop 0
    v_permlane32_swap_b32 v152, v154
    s_nop 1
    v_add_f32 v154, 0x358637bd, v154
    v_rcp_f32 v154, v154
    s_nop 0
    v_pk_mul_f32 v[168:169], v[192:193], v[154:155] op_sel_hi:[1,0]
    v_pk_mul_f32 v[170:171], v[194:195], v[154:155] op_sel_hi:[1,0]
    v_pk_mul_f32 v[172:173], v[196:197], v[154:155] op_sel_hi:[1,0]
    v_pk_mul_f32 v[174:175], v[198:199], v[154:155] op_sel_hi:[1,0]
    v_pk_mul_f32 v[176:177], v[200:201], v[154:155] op_sel_hi:[1,0]
    v_pk_mul_f32 v[178:179], v[202:203], v[154:155] op_sel_hi:[1,0]
    v_cvt_pk_bf16_f32 v160, v168, v169
    v_cvt_pk_bf16_f32 v161, v170, v171
    v_cvt_pk_bf16_f32 v162, v172, v173
    v_cvt_pk_bf16_f32 v163, v174, v175
    v_cvt_pk_bf16_f32 v164, v176, v177
    v_cvt_pk_bf16_f32 v165, v178, v179
    s_nop 0
    v_permlane32_swap_b32 v160, v162
    v_permlane32_swap_b32 v161, v163
    buffer_store_dwordx4 v[160:163], v235, s[8:11], s45 offen sc1
    s_mov_b32 exec_hi, 0
    buffer_store_dwordx2 v[164:165], v131, s[8:11], s45 offen sc1
    s_mov_b64 exec, -1
L2_np_fb0:
    s_branch L2_secretx
L2_sec7:
    s_cmp_eq_u32 s38, 0
    s_cbranch_scc0 L2_np_fb1
    s_lshl_b32 s44, s56, 3
    s_add_u32 s44, s44, s58
    s_mul_i32 s44, s44, 102400
    s_sub_u32 s45, s3, 0
    s_lshl_b32 s45, s45, 10
    s_add_u32 s44, s44, s45
    s_add_u32 m0, s45, 49152
    s_add_u32 s46, s44, 49152
    buffer_load_dwordx4 v130, s[24:27], s46 offen sc1 lds
    s_add_u32 m0, s45, 53248
    s_add_u32 s46, s44, 53248
    buffer_load_dwordx4 v130, s[24:27], s46 offen sc1 lds
    s_add_u32 m0, s45, 57344
    s_add_u32 s46, s44, 57344
    buffer_load_dwordx4 v130, s[24:27], s46 offen sc1 lds
    s_add_u32 m0, s45, 61440
    s_add_u32 s46, s44, 61440
    buffer_load_dwordx4 v130, s[24:27], s46 offen sc1 lds
    s_add_u32 m0, s45, 65536
    s_add_u32 s46, s44, 65536
    buffer_load_dwordx4 v130, s[24:27], s46 offen sc1 lds
    s_add_u32 m0, s45, 69632
    s_add_u32 s46, s44, 69632
    buffer_load_dwordx4 v130, s[24:27], s46 offen sc1 lds
    v_mfma_f32_32x32x16_bf16 v[192:207], v[240:243], v[132:135], 0
    v_mfma_f32_32x32x16_bf16 v[192:207], v[244:247], v[136:139], v[192:207]
    s_nop 15
    v_exp_f32 v152, -v192
    v_exp_f32 v192, v192
    v_exp_f32 v153, -v193
    v_exp_f32 v193, v193
    v_exp_f32 v154, -v194
    v_exp_f32 v194, v194
    v_exp_f32 v155, -v195
    v_exp_f32 v195, v195
    v_exp_f32 v156, -v196
    v_exp_f32 v196, v196
    v_exp_f32 v157, -v197
    v_exp_f32 v197, v197
    v_exp_f32 v158, -v198
    v_exp_f32 v198, v198
    v_exp_f32 v159, -v199
    v_exp_f32 v199, v199
    v_exp_f32 v160, -v200
    v_exp_f32 v200, v200
    v_exp_f32 v161, -v201
    v_exp_f32 v201, v201
    v_pk_add_f32 v[168:169], v[152:153], v[154:155]
    v_pk_add_f32 v[166:167], v[192:193], v[194:195]
    v_pk_add_f32 v[168:169], v[168:169], v[156:157]
    v_pk_add_f32 v[166:167], v[166:167], v[196:197]
    v_pk_add_f32 v[168:169], v[168:169], v[158:159]
    v_pk_add_f32 v[166:167], v[166:167], v[198:199]
    v_pk_add_f32 v[168:169], v[168:169], v[160:161]
    v_pk_add_f32 v[166:167], v[166:167], v[200:201]
    v_add_f32 v162, v166, v167
    v_add_f32 v163, v168, v169
    s_nop 1
    v_permlane32_swap_b32 v162, v163
    s_nop 1
    v_add_f32 v162, v162, v163
    v_mov_b32 v164, v162
    s_nop 1
    v_permlane32_swap_b32 v162, v164
    s_nop 1
    v_min_f32 v163, v162, v164
    v_max_f32 v165, v162, v164
    v_add_f32 v165, v165, v163
    s_mov_b32 s44, 0x1f800000
    s_mov_b32 s45, 0x5f800000
    v_cmp_nle_f32 vcc, s44, v163
    v_cmp_nge_f32 s[46:47], s45, v165
    s_nop 1
    s_or_b64 vcc, vcc, s[46:47]
    s_cbranch_vccz L2_fm_ok_f1
    v_mfma_f32_32x32x16_bf16 v[192:207], v[240:243], v[132:135], 0
    v_mfma_f32_32x32x16_bf16 v[192:207], v[244:247], v[136:139], v[192:207]
    s_nop 15
    v_max3_f32 v162, v192, v193, v194
    v_min3_f32 v163, v192, v193, v194
    v_max3_f32 v162, v162, v195, v196
    v_min3_f32 v163, v163, v195, v196
    v_max3_f32 v162, v162, v197, v198
    v_min3_f32 v163, v163, v197, v198
    v_max3_f32 v162, v162, v199, v200
    v_min3_f32 v163, v163, v199, v200
    v_max_f32 v162, v162, v201
    v_min_f32 v163, v163, v201
    v_mov_b32 v164, v162
    v_mov_b32 v165, v163
    s_nop 1
    v_permlane32_swap_b32 v162, v164
    v_permlane32_swap_b32 v163, v165
    s_nop 1
    v_max_f32 v164, v162, v164
    v_min_f32 v165, v163, v165
    v_sub_f32 v152, v165, v192
    v_sub_f32 v192, v192, v164
    v_sub_f32 v153, v165, v193
    v_sub_f32 v193, v193, v164
    v_sub_f32 v154, v165, v194
    v_sub_f32 v194, v194, v164
    v_sub_f32 v155, v165, v195
    v_sub_f32 v195, v195, v164
    v_sub_f32 v156, v165, v196
    v_sub_f32 v196, v196, v164
    v_sub_f32 v157, v165, v197
    v_sub_f32 v197, v197, v164
    v_sub_f32 v158, v165, v198
    v_sub_f32 v198, v198, v164
    v_sub_f32 v159, v165, v199
    v_sub_f32 v199, v199, v164
    v_sub_f32 v160, v165, v200
    v_sub_f32 v200, v200, v164
    v_sub_f32 v161, v165, v201
    v_sub_f32 v201, v201, v164
    v_exp_f32 v192, v192
    v_exp_f32 v152, v152
    v_exp_f32 v193, v193
    v_exp_f32 v153, v153
    v_exp_f32 v194, v194
    v_exp_f32 v154, v154
    v_exp_f32 v195, v195
    v_exp_f32 v155, v155
    v_exp_f32 v196, v196
    v_exp_f32 v156, v156
    v_exp_f32 v197, v197
    v_exp_f32 v157, v157
    v_exp_f32 v198, v198
    v_exp_f32 v158, v158
    v_exp_f32 v199, v199
    v_exp_f32 v159, v159
    v_exp_f32 v200, v200
    v_exp_f32 v160, v160
    v_exp_f32 v201, v201
    v_exp_f32 v161, v161
    s_nop 0
    v_pk_add_f32 v[168:169], v[152:153], v[154:155]
    v_pk_add_f32 v[166:167], v[192:193], v[194:195]
    v_pk_add_f32 v[168:169], v[168:169], v[156:157]
    v_pk_add_f32 v[166:167], v[166:167], v[196:197]
    v_pk_add_f32 v[168:169], v[168:169], v[158:159]
    v_pk_add_f32 v[166:167], v[166:167], v[198:199]
    v_pk_add_f32 v[168:169], v[168:169], v[160:161]
    v_pk_add_f32 v[166:167], v[166:167], v[200:201]
    v_add_f32 v162, v166, v167
    v_add_f32 v163, v168, v169
    s_nop 1
    v_permlane32_swap_b32 v162, v163
    s_nop 1
    v_add_f32 v162, v162, v163
    v_mov_b32 v164, v162
    s_nop 1
    v_permlane32_swap_b32 v162, v164
    s_nop 1
L2_fm_ok_f1:
    v_rcp_f32 v162, v162
    v_rcp_f32 v164, v164
    s_nop 0
    v_pk_mul_f32 v[192:193], v[192:193], v[162:163] op_sel_hi:[1,0]
    v_pk_mul_f32 v[152:153], v[152:153], v[164:165] op_sel_hi:[1,0]
    v_pk_mul_f32 v[194:195], v[194:195], v[162:163] op_sel_hi:[1,0]
    v_pk_mul_f32 v[154:155], v[154:155], v[164:165] op_sel_hi:[1,0]
    v_pk_mul_f32 v[196:197], v[196:197], v[162:163] op_sel_hi:[1,0]
    v_pk_mul_f32 v[156:157], v[156:157], v[164:165] op_sel_hi:[1,0]
    v_pk_mul_f32 v[198:199], v[198:199], v[162:163] op_sel_hi:[1,0]
    v_pk_mul_f32 v[158:159], v[158:159], v[164:165] op_sel_hi:[1,0]
    v_pk_mul_f32 v[200:201], v[200:201], v[162:163] op_sel_hi:[1,0]
    v_pk_mul_f32 v[160:161], v[160:161], v[164:165] op_sel_hi:[1,0]
    v_cvt_pk_bf16_f32 v140, v192, v193
    v_cvt_pk_bf16_f32 v145, v152, v153
    v_cvt_pk_bf16_f32 v141, v194, v195
    v_cvt_pk_bf16_f32 v146, v154, v155
    v_cvt_pk_bf16_f32 v142, v196, v197
    v_cvt_pk_bf16_f32 v147, v156, v157
    v_cvt_pk_bf16_f32 v143, v198, v199
    v_cvt_pk_bf16_f32 v148, v158, v159
    v_cvt_pk_bf16_f32 v144, v200, v201
    v_cvt_pk_bf16_f32 v149, v160, v161
    v_mov_b32 v150, 0
    v_mov_b32 v151, 0
    v_mul_u32_u24 v2, 48, v0
    v_add_u32 v2, 160768, v2
    ds_read_b128 v[208:211], v2 offset:0
    ds_read_b128 v[212:215], v2 offset:16
    ds_read_b128 v[216:219], v2 offset:32
    s_waitcnt lgkmcnt(0)
    v_mfma_f32_32x32x16_bf16 v[192:207], v[208:211], v[140:143], 0
    v_mfma_f32_32x32x16_bf16 v[192:207], v[212:215], v[144:147], v[192:207]
    v_mfma_f32_32x32x16_bf16 v[192:207], v[216:219], v[148:151], v[192:207]
    s_nop 15
    v_mov_b32 v152, v200
    v_mov_b32 v154, v200
    s_mov_b32 s45, 2662400
    s_nop 0
    v_permlane32_swap_b32 v152, v154
    s_nop 1
    v_add_f32 v154, 0x358637bd, v154
    v_rcp_f32 v154, v154
    s_nop 0
    v_pk_mul_f32 v[168:169], v[192:193], v[154:155] op_sel_hi:[1,0]
    v_pk_mul_f32 v[170:171], v[194:195], v[154:155] op_sel_hi:[1,0]
    v_pk_mul_f32 v[172:173], v[196:197], v[154:155] op_sel_hi:[1,0]
    v_pk_mul_f32 v[174:175], v[198:199], v[154:155] op_sel_hi:[1,0]
    v_pk_mul_f32 v[176:177], v[200:201], v[154:155] op_sel_hi:[1,0]
    v_pk_mul_f32 v[178:179], v[202:203], v[154:155] op_sel_hi:[1,0]
    v_cvt_pk_bf16_f32 v160, v168, v169
    v_cvt_pk_bf16_f32 v161, v170, v171
    v_cvt_pk_bf16_f32 v162, v172, v173
    v_cvt_pk_bf16_f32 v163, v174, v175
    v_cvt_pk_bf16_f32 v164, v176, v177
    v_cvt_pk_bf16_f32 v165, v178, v179
    s_nop 0
    v_permlane32_swap_b32 v160, v162
    v_permlane32_swap_b32 v161, v163
    buffer_store_dwordx4 v[160:163], v235, s[8:11], s45 offen sc1
    s_mov_b32 exec_hi, 0
    buffer_store_dwordx2 v[164:165], v131, s[8:11], s45 offen sc1
    s_mov_b64 exec, -1
L2_np_fb1:
    s_branch L2_secretx
L2_tail:
    s_waitcnt lgkmcnt(0)
    v_mfma_f32_32x32x16_bf16 v[36:51], v[120:123], v[88:91], v[36:51]
    s_lshl_b32 s46, s3, 12
    s_add_u32 s46, s46, 102400
    v_add_u32 v2, s46, v130
    s_xor_b32 s47, s3, 4
    s_lshl_b32 s47, s47, 12
    s_add_u32 s47, s47, 102400
    v_add_u32 v3, s47, v130
    s_nop 15
    s_cmp_eq_u32 s38, 0
    s_cbranch_scc0 L2_par1
    ds_write_b128 v2, v[36:39] offset:0
    ds_write_b128 v2, v[40:43] offset:1024
    ds_write_b128 v2, v[44:47] offset:2048
    ds_write_b128 v2, v[48:51] offset:3072
    s_branch L2_pard
L2_par1:
    ds_write_b128 v2, v[20:23] offset:0
    ds_write_b128 v2, v[24:27] offset:1024
    ds_write_b128 v2, v[28:31] offset:2048
    ds_write_b128 v2, v[32:35] offset:3072
L2_pard:
    s_waitcnt lgkmcnt(0)
    s_barrier
    ds_read_b128 v[192:195], v3 offset:0
    ds_read_b128 v[196:199], v3 offset:1024
    ds_read_b128 v[200:203], v3 offset:2048
    ds_read_b128 v[204:207], v3 offset:3072
    s_lshl_b32 s44, s56, 3
    s_add_u32 s44, s44, s58
    s_mul_i32 s44, s44, 102400
    s_sub_u32 s45, s3, 0
    s_lshl_b32 s45, s45, 10
    s_add_u32 s44, s44, s45
    s_add_u32 m0, s45, 73728
    s_add_u32 s46, s44, 73728
    buffer_load_dwordx4 v130, s[24:27], s46 offen sc1 lds
    s_add_u32 m0, s45, 81920
    s_add_u32 s46, s44, 81920
    buffer_load_dwordx4 v130, s[24:27], s46 offen sc1 lds
    s_add_u32 m0, s45, 90112
    s_add_u32 s46, s44, 90112
    buffer_load_dwordx4 v130, s[24:27], s46 offen sc1 lds
    s_cmp_ge_u32 s3, 4
    s_cselect_b32 s46, 1638400, s44
    s_cselect_b32 s47, 37888, s45
    s_add_u32 m0, s47, 98304
    s_add_u32 s46, s46, 98304
    buffer_load_dwordx4 v130, s[24:27], s46 offen sc1 lds
    s_cmp_eq_u32 s38, 0
    s_cbranch_scc0 L2_add1
    s_waitcnt lgkmcnt(0)
    v_pk_add_f32 v[168:169], v[20:21], v[192:193]
    v_pk_add_f32 v[170:171], v[22:23], v[194:195]
    v_pk_add_f32 v[172:173], v[24:25], v[196:197]
    v_pk_add_f32 v[174:175], v[26:27], v[198:199]
    v_pk_add_f32 v[176:177], v[28:29], v[200:201]
    v_pk_add_f32 v[178:179], v[30:31], v[202:203]
    v_pk_add_f32 v[180:181], v[32:33], v[204:205]
    v_pk_add_f32 v[182:183], v[34:35], v[206:207]
    s_branch L2_addd
L2_add1:
    s_waitcnt lgkmcnt(0)
    v_pk_add_f32 v[168:169], v[36:37], v[192:193]
    v_pk_add_f32 v[170:171], v[38:39], v[194:195]
    v_pk_add_f32 v[172:173], v[40:41], v[196:197]
    v_pk_add_f32 v[174:175], v[42:43], v[198:199]
    v_pk_add_f32 v[176:177], v[44:45], v[200:201]
    v_pk_add_f32 v[178:179], v[46:47], v[202:203]
    v_pk_add_f32 v[180:181], v[48:49], v[204:205]
    v_pk_add_f32 v[182:183], v[50:51], v[206:207]
L2_addd:
    v_mov_b32 v154, v176
    v_mov_b32 v155, v176
    v_mov_b32 v156, 0
    v_mov_b32 v157, 0
    v_permlane32_swap_b32 v154, v155
    v_pk_fma_f32 v[156:157], v[168:169], 0, v[156:157]
    v_pk_fma_f32 v[156:157], v[170:171], 0, v[156:157]
    v_pk_fma_f32 v[156:157], v[172:173], 0, v[156:157]
    v_pk_fma_f32 v[156:157], v[174:175], 0, v[156:157]
    v_pk_fma_f32 v[156:157], v[176:177], 0, v[156:157]
    v_pk_fma_f32 v[156:157], v[178:179], 0, v[156:157]
    s_mov_b32 s44, 0x1f800000
    s_mov_b32 s45, 0x5f800000
    v_cmp_nle_f32 vcc, s44, v155
    v_cmp_nge_f32 s[46:47], s45, v155
    v_cmp_u_f32 s[48:49], v156, v157
    s_nop 1
    s_or_b64 vcc, vcc, s[46:47]
    s_or_b64 vcc, vcc, s[48:49]
    s_cbranch_vccnz L2_slow
L2_adone:
    v_mov_b32 v152, v176
    v_mov_b32 v154, v176
    s_mov_b32 s45, 0
    s_nop 0
    v_permlane32_swap_b32 v152, v154
    s_nop 1
    v_rcp_f32 v154, v154
    s_nop 0
    v_pk_mul_f32 v[168:169], v[168:169], v[154:155] op_sel_hi:[1,0]
    v_pk_mul_f32 v[170:171], v[170:171], v[154:155] op_sel_hi:[1,0]
    v_pk_mul_f32 v[172:173], v[172:173], v[154:155] op_sel_hi:[1,0]
    v_pk_mul_f32 v[174:175], v[174:175], v[154:155] op_sel_hi:[1,0]
    v_pk_mul_f32 v[176:177], v[176:177], v[154:155] op_sel_hi:[1,0]
    v_pk_mul_f32 v[178:179], v[178:179], v[154:155] op_sel_hi:[1,0]
    v_cvt_pk_bf16_f32 v160, v168, v169
    v_cvt_pk_bf16_f32 v161, v170, v171
    v_cvt_pk_bf16_f32 v162, v172, v173
    v_cvt_pk_bf16_f32 v163, v174, v175
    v_cvt_pk_bf16_f32 v164, v176, v177
    v_cvt_pk_bf16_f32 v165, v178, v179
    s_nop 0
    v_permlane32_swap_b32 v160, v162
    v_permlane32_swap_b32 v161, v163
    buffer_store_dwordx4 v[160:163], v235, s[8:11], s45 offen sc1
    s_mov_b32 exec_hi, 0
    buffer_store_dwordx2 v[164:165], v131, s[8:11], s45 offen sc1
    s_mov_b64 exec, -1
    s_waitcnt vmcnt(0)
    s_barrier
    s_cmp_eq_u32 s3, 4
    s_cbranch_scc0 L3_nof3
    s_lshl_b32 s44, s30, 7
    s_add_u32 s44, s44, 131072
    v_mov_b32 v152, s44
    v_mov_b32 v153, s84
    s_mov_b64 exec, 1
    buffer_store_dword v153, v152, s[96:99], 0 offen sc1
    s_mov_b64 exec, -1
L3_nof3:
    s_cmp_eq_u32 s3, 4
    s_cbranch_scc0 L3_nosync
    s_lshr_b32 s46, s57, 1
    v_lshl_add_u32 v157, v0, 3, s46
    v_lshlrev_b32 v157, 7, v157
    v_add_u32 v157, 131072, v157
    s_mov_b32 s44, 0
L_poll_s2:
    s_mov_b32 exec_hi, 0x0
    buffer_load_dword v158, v157, s[96:99], 0 offen sc1
    s_waitcnt vmcnt(0)
    v_cmp_ne_u32 vcc, s84, v158
    s_mov_b64 exec, -1
    s_add_u32 s44, s44, 1
    s_cbranch_vccz L_polldone_s2
    s_cmp_lt_u32 s44, 0x100000
    s_cbranch_scc0 L_polldone_s2
    s_branch L_poll_s2
L_polldone_s2:
L3_nosync:
    s_cmp_ge_u32 s3, 4
    s_cbranch_scc0 L3_compute
    s_waitcnt vmcnt(0)
    s_barrier
    s_branch L_fin
L3_compute:
    v_lshlrev_b32 v1, 4, v0
    s_lshl_b32 s23, s56, 7
    s_lshl_b32 s24, s57, 3
    s_add_u32 s23, s23, s24
    s_mul_i32 s23, s23, 20480
    s_mov_b32 s12, s78
    s_mov_b32 s13, s79
    s_mov_b32 s14, 5242880
    s_mov_b32 s15, 0x00020000
    v_and_b32 v2, 15, v0
    v_lshrrev_b32 v3, 4, v0
    v_mul_u32_u24 v2, 160, v2
    v_lshl_add_u32 v2, v3, 3, v2
    s_mul_i32 s28, s3, 5120
    s_add_u32 s28, s28, 102400
    v_add_u32 v6, s28, v2
    v_add_u32 v7, s28, v1
    s_mov_b32 s29, 0x1999999a
    s_lshl_b32 s30, s57, 7
    s_lshl_b32 s31, s3, 5
    s_add_u32 s30, s30, s31
    s_mul_i32 s30, s30, 2560
    s_mul_i32 s31, s56, 1280
    s_add_u32 s30, s30, s31
    s_mul_i32 s31, s58, 160
    s_add_u32 s30, s30, s31
    v_add_u32 v2, 0, v0
    v_mul_hi_u32 v3, v2, s29
    v_mul_u32_u24 v4, 10, v3
    v_sub_u32 v4, v2, v4
    v_mul_u32_u24 v3, 2560, v3
    v_lshl_add_u32 v248, v4, 4, v3
    v_add_u32 v2, 64, v0
    v_mul_hi_u32 v3, v2, s29
    v_mul_u32_u24 v4, 10, v3
    v_sub_u32 v4, v2, v4
    v_mul_u32_u24 v3, 2560, v3
    v_lshl_add_u32 v249, v4, 4, v3
    v_add_u32 v2, 128, v0
    v_mul_hi_u32 v3, v2, s29
    v_mul_u32_u24 v4, 10, v3
    v_sub_u32 v4, v2, v4
    v_mul_u32_u24 v3, 2560, v3
    v_lshl_add_u32 v250, v4, 4, v3
    v_add_u32 v2, 192, v0
    v_mul_hi_u32 v3, v2, s29
    v_mul_u32_u24 v4, 10, v3
    v_sub_u32 v4, v2, v4
    v_mul_u32_u24 v3, 2560, v3
    v_lshl_add_u32 v251, v4, 4, v3
    v_add_u32 v2, 256, v0
    v_mul_hi_u32 v3, v2, s29
    v_mul_u32_u24 v4, 10, v3
    v_sub_u32 v4, v2, v4
    v_mul_u32_u24 v3, 2560, v3
    v_lshl_add_u32 v252, v4, 4, v3
    v_add_u32 v5, 61440, v1
    s_lshl_b32 s24, s3, 1
    s_mul_i32 s24, s24, 20480
    s_add_u32 s23, s23, s24
    s_add_u32 s24, s23, 20480
    s_waitcnt vmcnt(0)
    s_barrier
    s_add_u32 s27, s23, 0
    buffer_load_dwordx4 v[8:11], v1, s[8:11], s27 offen sc1
    s_add_u32 s28, s24, 0
    buffer_load_dwordx4 v[12:15], v1, s[8:11], s28 offen sc1
    s_add_u32 s27, s23, 1024
    buffer_load_dwordx4 v[16:19], v1, s[8:11], s27 offen sc1
    s_add_u32 s28, s24, 1024
    buffer_load_dwordx4 v[20:23], v1, s[8:11], s28 offen sc1
    s_add_u32 s27, s23, 2048
    buffer_load_dwordx4 v[24:27], v1, s[8:11], s27 offen sc1
    s_add_u32 s28, s24, 2048
    buffer_load_dwordx4 v[28:31], v1, s[8:11], s28 offen sc1
    s_add_u32 s27, s23, 3072
    buffer_load_dwordx4 v[32:35], v1, s[8:11], s27 offen sc1
    s_add_u32 s28, s24, 3072
    buffer_load_dwordx4 v[36:39], v1, s[8:11], s28 offen sc1
    s_add_u32 s27, s23, 4096
    buffer_load_dwordx4 v[40:43], v1, s[8:11], s27 offen sc1
    s_add_u32 s28, s24, 4096
    buffer_load_dwordx4 v[44:47], v1, s[8:11], s28 offen sc1
    ds_read_b128 v[208:211], v1 offset:0
    ds_read_b128 v[212:215], v1 offset:1024
    ds_read_b128 v[216:219], v1 offset:2048
    ds_read_b128 v[220:223], v1 offset:3072
    ds_read_b128 v[224:227], v1 offset:4096
    s_waitcnt vmcnt(8) lgkmcnt(0)
    v_mfma_f32_16x16x32_bf16 v[168:171], v[208:211], v[8:11], 0
    ds_read_b128 v[228:231], v1 offset:5120
    v_mfma_f32_16x16x32_bf16 v[188:191], v[208:211], v[12:15], 0
    ds_read_b128 v[232:235], v1 offset:6144
    v_mfma_f32_16x16x32_bf16 v[172:175], v[212:215], v[8:11], 0
    ds_read_b128 v[236:239], v1 offset:7168
    v_mfma_f32_16x16x32_bf16 v[192:195], v[212:215], v[12:15], 0
    ds_read_b128 v[240:243], v1 offset:8192
    v_mfma_f32_16x16x32_bf16 v[176:179], v[216:219], v[8:11], 0
    ds_read_b128 v[244:247], v1 offset:9216
    v_mfma_f32_16x16x32_bf16 v[196:199], v[216:219], v[12:15], 0
    s_add_u32 s27, s23, 5120
    buffer_load_dwordx4 v[48:51], v1, s[8:11], s27 offen sc1
    s_add_u32 s28, s24, 5120
    buffer_load_dwordx4 v[52:55], v1, s[8:11], s28 offen sc1
    v_mfma_f32_16x16x32_bf16 v[180:183], v[220:223], v[8:11], 0
    v_mfma_f32_16x16x32_bf16 v[200:203], v[220:223], v[12:15], 0
    v_mfma_f32_16x16x32_bf16 v[184:187], v[224:227], v[8:11], 0
    v_mfma_f32_16x16x32_bf16 v[204:207], v[224:227], v[12:15], 0
    s_waitcnt vmcnt(8) lgkmcnt(0)
    v_mfma_f32_16x16x32_bf16 v[168:171], v[228:231], v[16:19], v[168:171]
    ds_read_b128 v[208:211], v1 offset:10240
    v_mfma_f32_16x16x32_bf16 v[188:191], v[228:231], v[20:23], v[188:191]
    ds_read_b128 v[212:215], v1 offset:11264
    v_mfma_f32_16x16x32_bf16 v[172:175], v[232:235], v[16:19], v[172:175]
    ds_read_b128 v[216:219], v1 offset:12288
    v_mfma_f32_16x16x32_bf16 v[192:195], v[232:235], v[20:23], v[192:195]
    ds_read_b128 v[220:223], v1 offset:13312
    v_mfma_f32_16x16x32_bf16 v[176:179], v[236:239], v[16:19], v[176:179]
    ds_read_b128 v[224:227], v1 offset:14336
    v_mfma_f32_16x16x32_bf16 v[196:199], v[236:239], v[20:23], v[196:199]
    s_add_u32 s27, s23, 6144
    buffer_load_dwordx4 v[56:59], v1, s[8:11], s27 offen sc1
    s_add_u32 s28, s24, 6144
    buffer_load_dwordx4 v[60:63], v1, s[8:11], s28 offen sc1
    v_mfma_f32_16x16x32_bf16 v[180:183], v[240:243], v[16:19], v[180:183]
    v_mfma_f32_16x16x32_bf16 v[200:203], v[240:243], v[20:23], v[200:203]
    v_mfma_f32_16x16x32_bf16 v[184:187], v[244:247], v[16:19], v[184:187]
    v_mfma_f32_16x16x32_bf16 v[204:207], v[244:247], v[20:23], v[204:207]
    s_waitcnt vmcnt(8) lgkmcnt(0)
    v_mfma_f32_16x16x32_bf16 v[168:171], v[208:211], v[24:27], v[168:171]
    ds_read_b128 v[228:231], v1 offset:15360
    v_mfma_f32_16x16x32_bf16 v[188:191], v[208:211], v[28:31], v[188:191]
    ds_read_b128 v[232:235], v1 offset:16384
    v_mfma_f32_16x16x32_bf16 v[172:175], v[212:215], v[24:27], v[172:175]
    ds_read_b128 v[236:239], v1 offset:17408
    v_mfma_f32_16x16x32_bf16 v[192:195], v[212:215], v[28:31], v[192:195]
    ds_read_b128 v[240:243], v1 offset:18432
    v_mfma_f32_16x16x32_bf16 v[176:179], v[216:219], v[24:27], v[176:179]
    ds_read_b128 v[244:247], v1 offset:19456
    v_mfma_f32_16x16x32_bf16 v[196:199], v[216:219], v[28:31], v[196:199]
    s_add_u32 s27, s23, 7168
    buffer_load_dwordx4 v[64:67], v1, s[8:11], s27 offen sc1
    s_add_u32 s28, s24, 7168
    buffer_load_dwordx4 v[68:71], v1, s[8:11], s28 offen sc1
    v_mfma_f32_16x16x32_bf16 v[180:183], v[220:223], v[24:27], v[180:183]
    v_mfma_f32_16x16x32_bf16 v[200:203], v[220:223], v[28:31], v[200:203]
    v_mfma_f32_16x16x32_bf16 v[184:187], v[224:227], v[24:27], v[184:187]
    v_mfma_f32_16x16x32_bf16 v[204:207], v[224:227], v[28:31], v[204:207]
    s_waitcnt vmcnt(8) lgkmcnt(0)
    v_mfma_f32_16x16x32_bf16 v[168:171], v[228:231], v[32:35], v[168:171]
    ds_read_b128 v[208:211], v1 offset:20480
    v_mfma_f32_16x16x32_bf16 v[188:191], v[228:231], v[36:39], v[188:191]
    ds_read_b128 v[212:215], v1 offset:21504
    v_mfma_f32_16x16x32_bf16 v[172:175], v[232:235], v[32:35], v[172:175]
    ds_read_b128 v[216:219], v1 offset:22528
    v_mfma_f32_16x16x32_bf16 v[192:195], v[232:235], v[36:39], v[192:195]
    ds_read_b128 v[220:223], v1 offset:23552
    v_mfma_f32_16x16x32_bf16 v[176:179], v[236:239], v[32:35], v[176:179]
    ds_read_b128 v[224:227], v1 offset:24576
    v_mfma_f32_16x16x32_bf16 v[196:199], v[236:239], v[36:39], v[196:199]
    s_add_u32 s27, s23, 8192
    buffer_load_dwordx4 v[72:75], v1, s[8:11], s27 offen sc1
    s_add_u32 s28, s24, 8192
    buffer_load_dwordx4 v[76:79], v1, s[8:11], s28 offen sc1
    v_mfma_f32_16x16x32_bf16 v[180:183], v[240:243], v[32:35], v[180:183]
    v_mfma_f32_16x16x32_bf16 v[200:203], v[240:243], v[36:39], v[200:203]
    v_mfma_f32_16x16x32_bf16 v[184:187], v[244:247], v[32:35], v[184:187]
    v_mfma_f32_16x16x32_bf16 v[204:207], v[244:247], v[36:39], v[204:207]
    s_waitcnt vmcnt(8) lgkmcnt(0)
    v_mfma_f32_16x16x32_bf16 v[168:171], v[208:211], v[40:43], v[168:171]
    ds_read_b128 v[228:231], v1 offset:25600
    v_mfma_f32_16x16x32_bf16 v[188:191], v[208:211], v[44:47], v[188:191]
    ds_read_b128 v[232:235], v1 offset:26624
    v_mfma_f32_16x16x32_bf16 v[172:175], v[212:215], v[40:43], v[172:175]
    ds_read_b128 v[236:239], v1 offset:27648
    v_mfma_f32_16x16x32_bf16 v[192:195], v[212:215], v[44:47], v[192:195]
    ds_read_b128 v[240:243], v1 offset:28672
    v_mfma_f32_16x16x32_bf16 v[176:179], v[216:219], v[40:43], v[176:179]
    ds_read_b128 v[244:247], v1 offset:29696
    v_mfma_f32_16x16x32_bf16 v[196:199], v[216:219], v[44:47], v[196:199]
    s_add_u32 s27, s23, 9216
    buffer_load_dwordx4 v[80:83], v1, s[8:11], s27 offen sc1
    s_add_u32 s28, s24, 9216
    buffer_load_dwordx4 v[84:87], v1, s[8:11], s28 offen sc1
    v_mfma_f32_16x16x32_bf16 v[180:183], v[220:223], v[40:43], v[180:183]
    v_mfma_f32_16x16x32_bf16 v[200:203], v[220:223], v[44:47], v[200:203]
    v_mfma_f32_16x16x32_bf16 v[184:187], v[224:227], v[40:43], v[184:187]
    v_mfma_f32_16x16x32_bf16 v[204:207], v[224:227], v[44:47], v[204:207]
    s_waitcnt vmcnt(8) lgkmcnt(0)
    v_mfma_f32_16x16x32_bf16 v[168:171], v[228:231], v[48:51], v[168:171]
    ds_read_b128 v[208:211], v1 offset:30720
    v_mfma_f32_16x16x32_bf16 v[188:191], v[228:231], v[52:55], v[188:191]
    ds_read_b128 v[212:215], v1 offset:31744
    v_mfma_f32_16x16x32_bf16 v[172:175], v[232:235], v[48:51], v[172:175]
    ds_read_b128 v[216:219], v1 offset:32768
    v_mfma_f32_16x16x32_bf16 v[192:195], v[232:235], v[52:55], v[192:195]
    ds_read_b128 v[220:223], v1 offset:33792
    v_mfma_f32_16x16x32_bf16 v[176:179], v[236:239], v[48:51], v[176:179]
    ds_read_b128 v[224:227], v1 offset:34816
    v_mfma_f32_16x16x32_bf16 v[196:199], v[236:239], v[52:55], v[196:199]
    s_add_u32 s27, s23, 10240
    buffer_load_dwordx4 v[88:91], v1, s[8:11], s27 offen sc1
    s_add_u32 s28, s24, 10240
    buffer_load_dwordx4 v[92:95], v1, s[8:11], s28 offen sc1
    v_mfma_f32_16x16x32_bf16 v[180:183], v[240:243], v[48:51], v[180:183]
    v_mfma_f32_16x16x32_bf16 v[200:203], v[240:243], v[52:55], v[200:203]
    v_mfma_f32_16x16x32_bf16 v[184:187], v[244:247], v[48:51], v[184:187]
    v_mfma_f32_16x16x32_bf16 v[204:207], v[244:247], v[52:55], v[204:207]
    s_waitcnt vmcnt(8) lgkmcnt(0)
    v_mfma_f32_16x16x32_bf16 v[168:171], v[208:211], v[56:59], v[168:171]
    ds_read_b128 v[228:231], v1 offset:35840
    v_mfma_f32_16x16x32_bf16 v[188:191], v[208:211], v[60:63], v[188:191]
    ds_read_b128 v[232:235], v1 offset:36864
    v_mfma_f32_16x16x32_bf16 v[172:175], v[212:215], v[56:59], v[172:175]
    ds_read_b128 v[236:239], v1 offset:37888
    v_mfma_f32_16x16x32_bf16 v[192:195], v[212:215], v[60:63], v[192:195]
    ds_read_b128 v[240:243], v1 offset:38912
    v_mfma_f32_16x16x32_bf16 v[176:179], v[216:219], v[56:59], v[176:179]
    ds_read_b128 v[244:247], v1 offset:39936
    v_mfma_f32_16x16x32_bf16 v[196:199], v[216:219], v[60:63], v[196:199]
    s_add_u32 s27, s23, 11264
    buffer_load_dwordx4 v[96:99], v1, s[8:11], s27 offen sc1
    s_add_u32 s28, s24, 11264
    buffer_load_dwordx4 v[100:103], v1, s[8:11], s28 offen sc1
    v_mfma_f32_16x16x32_bf16 v[180:183], v[220:223], v[56:59], v[180:183]
    v_mfma_f32_16x16x32_bf16 v[200:203], v[220:223], v[60:63], v[200:203]
    v_mfma_f32_16x16x32_bf16 v[184:187], v[224:227], v[56:59], v[184:187]
    v_mfma_f32_16x16x32_bf16 v[204:207], v[224:227], v[60:63], v[204:207]
    s_waitcnt vmcnt(8) lgkmcnt(0)
    v_mfma_f32_16x16x32_bf16 v[168:171], v[228:231], v[64:67], v[168:171]
    ds_read_b128 v[208:211], v1 offset:40960
    v_mfma_f32_16x16x32_bf16 v[188:191], v[228:231], v[68:71], v[188:191]
    ds_read_b128 v[212:215], v1 offset:41984
    v_mfma_f32_16x16x32_bf16 v[172:175], v[232:235], v[64:67], v[172:175]
    ds_read_b128 v[216:219], v1 offset:43008
    v_mfma_f32_16x16x32_bf16 v[192:195], v[232:235], v[68:71], v[192:195]
    ds_read_b128 v[220:223], v1 offset:44032
    v_mfma_f32_16x16x32_bf16 v[176:179], v[236:239], v[64:67], v[176:179]
    ds_read_b128 v[224:227], v1 offset:45056
    v_mfma_f32_16x16x32_bf16 v[196:199], v[236:239], v[68:71], v[196:199]
    s_add_u32 s27, s23, 12288
    buffer_load_dwordx4 v[104:107], v1, s[8:11], s27 offen sc1
    s_add_u32 s28, s24, 12288
    buffer_load_dwordx4 v[108:111], v1, s[8:11], s28 offen sc1
    v_mfma_f32_16x16x32_bf16 v[180:183], v[240:243], v[64:67], v[180:183]
    v_mfma_f32_16x16x32_bf16 v[200:203], v[240:243], v[68:71], v[200:203]
    v_mfma_f32_16x16x32_bf16 v[184:187], v[244:247], v[64:67], v[184:187]
    v_mfma_f32_16x16x32_bf16 v[204:207], v[244:247], v[68:71], v[204:207]
    s_waitcnt vmcnt(8) lgkmcnt(0)
    v_mfma_f32_16x16x32_bf16 v[168:171], v[208:211], v[72:75], v[168:171]
    ds_read_b128 v[228:231], v1 offset:46080
    v_mfma_f32_16x16x32_bf16 v[188:191], v[208:211], v[76:79], v[188:191]
    ds_read_b128 v[232:235], v1 offset:47104
    v_mfma_f32_16x16x32_bf16 v[172:175], v[212:215], v[72:75], v[172:175]
    ds_read_b128 v[236:239], v1 offset:48128
    v_mfma_f32_16x16x32_bf16 v[192:195], v[212:215], v[76:79], v[192:195]
    ds_read_b128 v[240:243], v1 offset:49152
    v_mfma_f32_16x16x32_bf16 v[176:179], v[216:219], v[72:75], v[176:179]
    ds_read_b128 v[244:247], v1 offset:50176
    v_mfma_f32_16x16x32_bf16 v[196:199], v[216:219], v[76:79], v[196:199]
    s_add_u32 s27, s23, 13312
    buffer_load_dwordx4 v[112:115], v1, s[8:11], s27 offen sc1
    s_add_u32 s28, s24, 13312
    buffer_load_dwordx4 v[116:119], v1, s[8:11], s28 offen sc1
    v_mfma_f32_16x16x32_bf16 v[180:183], v[220:223], v[72:75], v[180:183]
    v_mfma_f32_16x16x32_bf16 v[200:203], v[220:223], v[76:79], v[200:203]
    v_mfma_f32_16x16x32_bf16 v[184:187], v[224:227], v[72:75], v[184:187]
    v_mfma_f32_16x16x32_bf16 v[204:207], v[224:227], v[76:79], v[204:207]
    s_waitcnt vmcnt(8) lgkmcnt(0)
    v_mfma_f32_16x16x32_bf16 v[168:171], v[228:231], v[80:83], v[168:171]
    ds_read_b128 v[208:211], v1 offset:51200
    v_mfma_f32_16x16x32_bf16 v[188:191], v[228:231], v[84:87], v[188:191]
    ds_read_b128 v[212:215], v1 offset:52224
    v_mfma_f32_16x16x32_bf16 v[172:175], v[232:235], v[80:83], v[172:175]
    ds_read_b128 v[216:219], v1 offset:53248
    v_mfma_f32_16x16x32_bf16 v[192:195], v[232:235], v[84:87], v[192:195]
    ds_read_b128 v[220:223], v1 offset:54272
    v_mfma_f32_16x16x32_bf16 v[176:179], v[236:239], v[80:83], v[176:179]
    ds_read_b128 v[224:227], v1 offset:55296
    v_mfma_f32_16x16x32_bf16 v[196:199], v[236:239], v[84:87], v[196:199]
    s_add_u32 s27, s23, 14336
    buffer_load_dwordx4 v[120:123], v1, s[8:11], s27 offen sc1
    s_add_u32 s28, s24, 14336
    buffer_load_dwordx4 v[124:127], v1, s[8:11], s28 offen sc1
    v_mfma_f32_16x16x32_bf16 v[180:183], v[240:243], v[80:83], v[180:183]
    v_mfma_f32_16x16x32_bf16 v[200:203], v[240:243], v[84:87], v[200:203]
    v_mfma_f32_16x16x32_bf16 v[184:187], v[244:247], v[80:83], v[184:187]
    v_mfma_f32_16x16x32_bf16 v[204:207], v[244:247], v[84:87], v[204:207]
    s_waitcnt vmcnt(8) lgkmcnt(0)
    v_mfma_f32_16x16x32_bf16 v[168:171], v[208:211], v[88:91], v[168:171]
    ds_read_b128 v[228:231], v1 offset:56320
    v_mfma_f32_16x16x32_bf16 v[188:191], v[208:211], v[92:95], v[188:191]
    ds_read_b128 v[232:235], v1 offset:57344
    v_mfma_f32_16x16x32_bf16 v[172:175], v[212:215], v[88:91], v[172:175]
    ds_read_b128 v[236:239], v1 offset:58368
    v_mfma_f32_16x16x32_bf16 v[192:195], v[212:215], v[92:95], v[192:195]
    ds_read_b128 v[240:243], v1 offset:59392
    v_mfma_f32_16x16x32_bf16 v[176:179], v[216:219], v[88:91], v[176:179]
    ds_read_b128 v[244:247], v1 offset:60416
    v_mfma_f32_16x16x32_bf16 v[196:199], v[216:219], v[92:95], v[196:199]
    s_add_u32 s27, s23, 15360
    buffer_load_dwordx4 v[128:131], v1, s[8:11], s27 offen sc1
    s_add_u32 s28, s24, 15360
    buffer_load_dwordx4 v[132:135], v1, s[8:11], s28 offen sc1
    v_mfma_f32_16x16x32_bf16 v[180:183], v[220:223], v[88:91], v[180:183]
    v_mfma_f32_16x16x32_bf16 v[200:203], v[220:223], v[92:95], v[200:203]
    v_mfma_f32_16x16x32_bf16 v[184:187], v[224:227], v[88:91], v[184:187]
    v_mfma_f32_16x16x32_bf16 v[204:207], v[224:227], v[92:95], v[204:207]
    s_waitcnt vmcnt(8) lgkmcnt(0)
    v_mfma_f32_16x16x32_bf16 v[168:171], v[228:231], v[96:99], v[168:171]
    ds_read_b128 v[208:211], v5 offset:0
    v_mfma_f32_16x16x32_bf16 v[188:191], v[228:231], v[100:103], v[188:191]
    ds_read_b128 v[212:215], v5 offset:1024
    v_mfma_f32_16x16x32_bf16 v[172:175], v[232:235], v[96:99], v[172:175]
    ds_read_b128 v[216:219], v5 offset:2048
    v_mfma_f32_16x16x32_bf16 v[192:195], v[232:235], v[100:103], v[192:195]
    ds_read_b128 v[220:223], v5 offset:3072
    v_mfma_f32_16x16x32_bf16 v[176:179], v[236:239], v[96:99], v[176:179]
    ds_read_b128 v[224:227], v5 offset:4096
    v_mfma_f32_16x16x32_bf16 v[196:199], v[236:239], v[100:103], v[196:199]
    s_add_u32 s27, s23, 16384
    buffer_load_dwordx4 v[136:139], v1, s[8:11], s27 offen sc1
    s_add_u32 s28, s24, 16384
    buffer_load_dwordx4 v[140:143], v1, s[8:11], s28 offen sc1
    v_mfma_f32_16x16x32_bf16 v[180:183], v[240:243], v[96:99], v[180:183]
    v_mfma_f32_16x16x32_bf16 v[200:203], v[240:243], v[100:103], v[200:203]
    v_mfma_f32_16x16x32_bf16 v[184:187], v[244:247], v[96:99], v[184:187]
    v_mfma_f32_16x16x32_bf16 v[204:207], v[244:247], v[100:103], v[204:207]
    s_waitcnt vmcnt(8) lgkmcnt(0)
    v_mfma_f32_16x16x32_bf16 v[168:171], v[208:211], v[104:107], v[168:171]
    ds_read_b128 v[228:231], v5 offset:5120
    v_mfma_f32_16x16x32_bf16 v[188:191], v[208:211], v[108:111], v[188:191]
    ds_read_b128 v[232:235], v5 offset:6144
    v_mfma_f32_16x16x32_bf16 v[172:175], v[212:215], v[104:107], v[172:175]
    ds_read_b128 v[236:239], v5 offset:7168
    v_mfma_f32_16x16x32_bf16 v[192:195], v[212:215], v[108:111], v[192:195]
    ds_read_b128 v[240:243], v5 offset:8192
    v_mfma_f32_16x16x32_bf16 v[176:179], v[216:219], v[104:107], v[176:179]
    ds_read_b128 v[244:247], v5 offset:9216
    v_mfma_f32_16x16x32_bf16 v[196:199], v[216:219], v[108:111], v[196:199]
    s_add_u32 s27, s23, 17408
    buffer_load_dwordx4 v[144:147], v1, s[8:11], s27 offen sc1
    s_add_u32 s28, s24, 17408
    buffer_load_dwordx4 v[148:151], v1, s[8:11], s28 offen sc1
    v_mfma_f32_16x16x32_bf16 v[180:183], v[220:223], v[104:107], v[180:183]
    v_mfma_f32_16x16x32_bf16 v[200:203], v[220:223], v[108:111], v[200:203]
    v_mfma_f32_16x16x32_bf16 v[184:187], v[224:227], v[104:107], v[184:187]
    v_mfma_f32_16x16x32_bf16 v[204:207], v[224:227], v[108:111], v[204:207]
    s_waitcnt vmcnt(8) lgkmcnt(0)
    v_mfma_f32_16x16x32_bf16 v[168:171], v[228:231], v[112:115], v[168:171]
    ds_read_b128 v[208:211], v5 offset:10240
    v_mfma_f32_16x16x32_bf16 v[188:191], v[228:231], v[116:119], v[188:191]
    ds_read_b128 v[212:215], v5 offset:11264
    v_mfma_f32_16x16x32_bf16 v[172:175], v[232:235], v[112:115], v[172:175]
    ds_read_b128 v[216:219], v5 offset:12288
    v_mfma_f32_16x16x32_bf16 v[192:195], v[232:235], v[116:119], v[192:195]
    ds_read_b128 v[220:223], v5 offset:13312
    v_mfma_f32_16x16x32_bf16 v[176:179], v[236:239], v[112:115], v[176:179]
    ds_read_b128 v[224:227], v5 offset:14336
    v_mfma_f32_16x16x32_bf16 v[196:199], v[236:239], v[116:119], v[196:199]
    s_add_u32 s27, s23, 18432
    buffer_load_dwordx4 v[152:155], v1, s[8:11], s27 offen sc1
    s_add_u32 s28, s24, 18432
    buffer_load_dwordx4 v[156:159], v1, s[8:11], s28 offen sc1
    v_mfma_f32_16x16x32_bf16 v[180:183], v[240:243], v[112:115], v[180:183]
    v_mfma_f32_16x16x32_bf16 v[200:203], v[240:243], v[116:119], v[200:203]
    v_mfma_f32_16x16x32_bf16 v[184:187], v[244:247], v[112:115], v[184:187]
    v_mfma_f32_16x16x32_bf16 v[204:207], v[244:247], v[116:119], v[204:207]
    s_waitcnt vmcnt(8) lgkmcnt(0)
    v_mfma_f32_16x16x32_bf16 v[168:171], v[208:211], v[120:123], v[168:171]
    ds_read_b128 v[228:231], v5 offset:15360
    v_mfma_f32_16x16x32_bf16 v[188:191], v[208:211], v[124:127], v[188:191]
    ds_read_b128 v[232:235], v5 offset:16384
    v_mfma_f32_16x16x32_bf16 v[172:175], v[212:215], v[120:123], v[172:175]
    ds_read_b128 v[236:239], v5 offset:17408
    v_mfma_f32_16x16x32_bf16 v[192:195], v[212:215], v[124:127], v[192:195]
    ds_read_b128 v[240:243], v5 offset:18432
    v_mfma_f32_16x16x32_bf16 v[176:179], v[216:219], v[120:123], v[176:179]
    ds_read_b128 v[244:247], v5 offset:19456
    v_mfma_f32_16x16x32_bf16 v[196:199], v[216:219], v[124:127], v[196:199]
    s_add_u32 s27, s23, 19456
    buffer_load_dwordx4 v[160:163], v1, s[8:11], s27 offen sc1
    s_add_u32 s28, s24, 19456
    buffer_load_dwordx4 v[164:167], v1, s[8:11], s28 offen sc1
    v_mfma_f32_16x16x32_bf16 v[180:183], v[220:223], v[120:123], v[180:183]
    v_mfma_f32_16x16x32_bf16 v[200:203], v[220:223], v[124:127], v[200:203]
    v_mfma_f32_16x16x32_bf16 v[184:187], v[224:227], v[120:123], v[184:187]
    v_mfma_f32_16x16x32_bf16 v[204:207], v[224:227], v[124:127], v[204:207]
    s_waitcnt vmcnt(8) lgkmcnt(0)
    v_mfma_f32_16x16x32_bf16 v[168:171], v[228:231], v[128:131], v[168:171]
    ds_read_b128 v[208:211], v5 offset:20480
    v_mfma_f32_16x16x32_bf16 v[188:191], v[228:231], v[132:135], v[188:191]
    ds_read_b128 v[212:215], v5 offset:21504
    v_mfma_f32_16x16x32_bf16 v[172:175], v[232:235], v[128:131], v[172:175]
    ds_read_b128 v[216:219], v5 offset:22528
    v_mfma_f32_16x16x32_bf16 v[192:195], v[232:235], v[132:135], v[192:195]
    ds_read_b128 v[220:223], v5 offset:23552
    v_mfma_f32_16x16x32_bf16 v[176:179], v[236:239], v[128:131], v[176:179]
    ds_read_b128 v[224:227], v5 offset:24576
    v_mfma_f32_16x16x32_bf16 v[196:199], v[236:239], v[132:135], v[196:199]
    v_mfma_f32_16x16x32_bf16 v[180:183], v[240:243], v[128:131], v[180:183]
    v_mfma_f32_16x16x32_bf16 v[200:203], v[240:243], v[132:135], v[200:203]
    v_mfma_f32_16x16x32_bf16 v[184:187], v[244:247], v[128:131], v[184:187]
    v_mfma_f32_16x16x32_bf16 v[204:207], v[244:247], v[132:135], v[204:207]
    s_waitcnt vmcnt(6) lgkmcnt(0)
    v_mfma_f32_16x16x32_bf16 v[168:171], v[208:211], v[136:139], v[168:171]
    ds_read_b128 v[228:231], v5 offset:25600
    v_mfma_f32_16x16x32_bf16 v[188:191], v[208:211], v[140:143], v[188:191]
    ds_read_b128 v[232:235], v5 offset:26624
    v_mfma_f32_16x16x32_bf16 v[172:175], v[212:215], v[136:139], v[172:175]
    ds_read_b128 v[236:239], v5 offset:27648
    v_mfma_f32_16x16x32_bf16 v[192:195], v[212:215], v[140:143], v[192:195]
    ds_read_b128 v[240:243], v5 offset:28672
    v_mfma_f32_16x16x32_bf16 v[176:179], v[216:219], v[136:139], v[176:179]
    ds_read_b128 v[244:247], v5 offset:29696
    v_mfma_f32_16x16x32_bf16 v[196:199], v[216:219], v[140:143], v[196:199]
    v_mfma_f32_16x16x32_bf16 v[180:183], v[220:223], v[136:139], v[180:183]
    v_mfma_f32_16x16x32_bf16 v[200:203], v[220:223], v[140:143], v[200:203]
    v_mfma_f32_16x16x32_bf16 v[184:187], v[224:227], v[136:139], v[184:187]
    v_mfma_f32_16x16x32_bf16 v[204:207], v[224:227], v[140:143], v[204:207]
    s_waitcnt vmcnt(4) lgkmcnt(0)
    v_mfma_f32_16x16x32_bf16 v[168:171], v[228:231], v[144:147], v[168:171]
    ds_read_b128 v[208:211], v5 offset:30720
    v_mfma_f32_16x16x32_bf16 v[188:191], v[228:231], v[148:151], v[188:191]
    ds_read_b128 v[212:215], v5 offset:31744
    v_mfma_f32_16x16x32_bf16 v[172:175], v[232:235], v[144:147], v[172:175]
    ds_read_b128 v[216:219], v5 offset:32768
    v_mfma_f32_16x16x32_bf16 v[192:195], v[232:235], v[148:151], v[192:195]
    ds_read_b128 v[220:223], v5 offset:33792
    v_mfma_f32_16x16x32_bf16 v[176:179], v[236:239], v[144:147], v[176:179]
    ds_read_b128 v[224:227], v5 offset:34816
    v_mfma_f32_16x16x32_bf16 v[196:199], v[236:239], v[148:151], v[196:199]
    v_mfma_f32_16x16x32_bf16 v[180:183], v[240:243], v[144:147], v[180:183]
    v_mfma_f32_16x16x32_bf16 v[200:203], v[240:243], v[148:151], v[200:203]
    v_mfma_f32_16x16x32_bf16 v[184:187], v[244:247], v[144:147], v[184:187]
    v_mfma_f32_16x16x32_bf16 v[204:207], v[244:247], v[148:151], v[204:207]
    s_waitcnt vmcnt(2) lgkmcnt(0)
    v_mfma_f32_16x16x32_bf16 v[168:171], v[208:211], v[152:155], v[168:171]
    ds_read_b128 v[228:231], v5 offset:35840
    v_mfma_f32_16x16x32_bf16 v[188:191], v[208:211], v[156:159], v[188:191]
    ds_read_b128 v[232:235], v5 offset:36864
    v_mfma_f32_16x16x32_bf16 v[172:175], v[212:215], v[152:155], v[172:175]
    ds_read_b128 v[236:239], v5 offset:37888
    v_mfma_f32_16x16x32_bf16 v[192:195], v[212:215], v[156:159], v[192:195]
    ds_read_b128 v[240:243], v5 offset:38912
    v_mfma_f32_16x16x32_bf16 v[176:179], v[216:219], v[152:155], v[176:179]
    ds_read_b128 v[244:247], v5 offset:39936
    v_mfma_f32_16x16x32_bf16 v[196:199], v[216:219], v[156:159], v[196:199]
    v_mfma_f32_16x16x32_bf16 v[180:183], v[220:223], v[152:155], v[180:183]
    v_mfma_f32_16x16x32_bf16 v[200:203], v[220:223], v[156:159], v[200:203]
    v_mfma_f32_16x16x32_bf16 v[184:187], v[224:227], v[152:155], v[184:187]
    v_mfma_f32_16x16x32_bf16 v[204:207], v[224:227], v[156:159], v[204:207]
    s_waitcnt vmcnt(0) lgkmcnt(0)
    v_mfma_f32_16x16x32_bf16 v[168:171], v[228:231], v[160:163], v[168:171]
    v_mfma_f32_16x16x32_bf16 v[188:191], v[228:231], v[164:167], v[188:191]
    v_mfma_f32_16x16x32_bf16 v[172:175], v[232:235], v[160:163], v[172:175]
    v_mfma_f32_16x16x32_bf16 v[192:195], v[232:235], v[164:167], v[192:195]
    v_mfma_f32_16x16x32_bf16 v[176:179], v[236:239], v[160:163], v[176:179]
    v_mfma_f32_16x16x32_bf16 v[196:199], v[236:239], v[164:167], v[196:199]
    v_mfma_f32_16x16x32_bf16 v[180:183], v[240:243], v[160:163], v[180:183]
    v_mfma_f32_16x16x32_bf16 v[200:203], v[240:243], v[164:167], v[200:203]
    v_mfma_f32_16x16x32_bf16 v[184:187], v[244:247], v[160:163], v[184:187]
    v_mfma_f32_16x16x32_bf16 v[204:207], v[244:247], v[164:167], v[204:207]
    s_nop 7
    v_cvt_pk_bf16_f32 v16, v168, v169
    v_cvt_pk_bf16_f32 v17, v170, v171
    ds_write_b64 v6, v[16:17] offset:0
    v_cvt_pk_bf16_f32 v18, v172, v173
    v_cvt_pk_bf16_f32 v19, v174, v175
    ds_write_b64 v6, v[18:19] offset:32
    v_cvt_pk_bf16_f32 v20, v176, v177
    v_cvt_pk_bf16_f32 v21, v178, v179
    ds_write_b64 v6, v[20:21] offset:64
    v_cvt_pk_bf16_f32 v22, v180, v181
    v_cvt_pk_bf16_f32 v23, v182, v183
    ds_write_b64 v6, v[22:23] offset:96
    v_cvt_pk_bf16_f32 v24, v184, v185
    v_cvt_pk_bf16_f32 v25, v186, v187
    ds_write_b64 v6, v[24:25] offset:128
    v_cvt_pk_bf16_f32 v26, v188, v189
    v_cvt_pk_bf16_f32 v27, v190, v191
    ds_write_b64 v6, v[26:27] offset:2560
    v_cvt_pk_bf16_f32 v28, v192, v193
    v_cvt_pk_bf16_f32 v29, v194, v195
    ds_write_b64 v6, v[28:29] offset:2592
    v_cvt_pk_bf16_f32 v30, v196, v197
    v_cvt_pk_bf16_f32 v31, v198, v199
    ds_write_b64 v6, v[30:31] offset:2624
    v_cvt_pk_bf16_f32 v32, v200, v201
    v_cvt_pk_bf16_f32 v33, v202, v203
    ds_write_b64 v6, v[32:33] offset:2656
    v_cvt_pk_bf16_f32 v34, v204, v205
    v_cvt_pk_bf16_f32 v35, v206, v207
    ds_write_b64 v6, v[34:35] offset:2688
    s_waitcnt lgkmcnt(0)
    ds_read_b128 v[56:59], v7 offset:0
    ds_read_b128 v[60:63], v7 offset:1024
    ds_read_b128 v[64:67], v7 offset:2048
    ds_read_b128 v[68:71], v7 offset:3072
    ds_read_b128 v[72:75], v7 offset:4096
    s_waitcnt lgkmcnt(4)
    buffer_store_dwordx4 v[56:59], v248, s[12:15], s30 offen nt
    s_waitcnt lgkmcnt(3)
    buffer_store_dwordx4 v[60:63], v249, s[12:15], s30 offen nt
    s_waitcnt lgkmcnt(2)
    buffer_store_dwordx4 v[64:67], v250, s[12:15], s30 offen nt
    s_waitcnt lgkmcnt(1)
    buffer_store_dwordx4 v[68:71], v251, s[12:15], s30 offen nt
    s_waitcnt lgkmcnt(0)
    buffer_store_dwordx4 v[72:75], v252, s[12:15], s30 offen nt
L_fin:
    s_endpgm
L2_slow:
    s_waitcnt vmcnt(0) lgkmcnt(0)
    v_mov_b32 v20, 0
    v_mov_b32 v21, 0
    v_mov_b32 v22, 0
    v_mov_b32 v23, 0
    v_mov_b32 v24, 0
    v_mov_b32 v25, 0
    v_mov_b32 v26, 0
    v_mov_b32 v27, 0
    v_mov_b32 v28, 0
    v_mov_b32 v29, 0
    v_mov_b32 v30, 0
    v_mov_b32 v31, 0
    v_mov_b32 v32, 0
    v_mov_b32 v33, 0
    v_mov_b32 v34, 0
    v_mov_b32 v35, 0
    v_mov_b32 v162, 0xff7fffff
    s_cmp_eq_u32 s38, 0
    s_cbranch_scc1 L2_slow_q0
    v_mov_b32 v4, v8
    v_mov_b32 v12, v16
    v_mov_b32 v5, v9
    v_mov_b32 v13, v17
    v_mov_b32 v6, v10
    v_mov_b32 v14, v18
    v_mov_b32 v7, v11
    v_mov_b32 v15, v19
L2_slow_q0:
    v_and_b32 v1, 31, v0
    v_lshrrev_b32 v2, 5, v0
    v_and_b32 v3, 19, v1
    v_bfe_u32 v156, v1, 2, 1
    v_lshl_or_b32 v3, v156, 3, v3
    v_bfe_u32 v156, v1, 3, 1
    v_lshl_or_b32 v3, v156, 2, v3
    v_lshlrev_b32 v3, 4, v3
    v_mul_u32_u24 v156, 32768, v2
    v_add_u32 v124, v3, v156
    v_add_u32 v125, 65536, v3
    v_lshlrev_b32 v3, 4, v1
    v_add_u32 v127, v3, v156
    v_add_u32 v128, 65536, v3
    s_mul_i32 s46, s3, 1536
    s_add_u32 s46, s46, 137216
    v_bfe_u32 v156, v0, 2, 2
    v_lshl_add_u32 v156, v2, 3, v156
    v_lshlrev_b32 v156, 4, v156
    v_bfe_u32 v157, v0, 4, 1
    v_and_b32 v158, 3, v0
    v_lshl_add_u32 v157, v157, 2, v158
    v_lshrrev_b32 v158, 1, v157
    v_min_u32 v158, 2, v158
    v_and_b32 v157, 1, v157
    v_lshl_add_u32 v156, v157, 3, v156
    v_lshl_add_u32 v156, v158, 9, v156
    v_add_u32 v126, s46, v156
    s_add_u32 s47, s85, 32
    s_mul_i32 s47, s47, 98304
    s_add_u32 s48, s47, 3145728
    s_mov_b32 s42, 0
L2_slow_tile:
    buffer_load_dwordx4 v[92:95], v124, s[16:19], s47 offen sc1
    buffer_load_dwordx2 v[100:101], v125, s[16:19], s47 offen sc1
    s_mov_b32 m0, s46
    s_sub_u32 s49, s48, 1024
    buffer_load_dwordx4 v127, s[16:19], s48 offen sc1 lds
    s_mov_b32 exec_hi, 0
    buffer_load_dwordx4 v128, s[16:19], s49 offen offset:1024 sc1 lds
    s_mov_b64 exec, -1
    s_waitcnt vmcnt(0)
    ds_read_b64_tr_b16 v[108:109], v126 offset:0
    ds_read_b64_tr_b16 v[110:111], v126 offset:64
    ds_read_b64_tr_b16 v[112:113], v126 offset:256
    ds_read_b64_tr_b16 v[114:115], v126 offset:320
    v_mfma_f32_32x32x16_bf16 v[52:67], v[92:95], v[4:7], 0
    v_mfma_f32_32x32x8_bf16 v[52:67], v[100:101], v[12:13], v[52:67]
    s_nop 15
    v_max3_f32 v164, v52, v53, v54
    v_max3_f32 v164, v164, v55, v56
    v_max3_f32 v164, v164, v57, v58
    v_max3_f32 v164, v164, v59, v60
    v_max3_f32 v164, v164, v61, v62
    v_max3_f32 v164, v164, v63, v64
    v_max3_f32 v164, v164, v65, v66
    v_max_f32 v164, v164, v67
    v_mov_b32 v165, v164
    s_nop 1
    v_permlane32_swap_b32 v164, v165
    s_nop 1
    v_max3_f32 v164, v164, v165, v162
    v_sub_f32 v163, v162, v164
    v_exp_f32 v163, v163
    v_mov_b32 v162, v164
    v_sub_f32 v52, v52, v164
    v_sub_f32 v53, v53, v164
    v_sub_f32 v54, v54, v164
    v_sub_f32 v55, v55, v164
    v_sub_f32 v56, v56, v164
    v_sub_f32 v57, v57, v164
    v_sub_f32 v58, v58, v164
    v_sub_f32 v59, v59, v164
    v_sub_f32 v60, v60, v164
    v_sub_f32 v61, v61, v164
    v_sub_f32 v62, v62, v164
    v_sub_f32 v63, v63, v164
    v_sub_f32 v64, v64, v164
    v_sub_f32 v65, v65, v164
    v_sub_f32 v66, v66, v164
    v_sub_f32 v67, v67, v164
    v_exp_f32 v52, v52
    v_exp_f32 v53, v53
    v_exp_f32 v54, v54
    v_exp_f32 v55, v55
    v_exp_f32 v56, v56
    v_exp_f32 v57, v57
    v_exp_f32 v58, v58
    v_exp_f32 v59, v59
    v_exp_f32 v60, v60
    v_exp_f32 v61, v61
    v_exp_f32 v62, v62
    v_exp_f32 v63, v63
    v_exp_f32 v64, v64
    v_exp_f32 v65, v65
    v_exp_f32 v66, v66
    v_exp_f32 v67, v67
    v_mul_f32 v20, v20, v163
    v_mul_f32 v21, v21, v163
    v_mul_f32 v22, v22, v163
    v_mul_f32 v23, v23, v163
    v_mul_f32 v24, v24, v163
    v_mul_f32 v25, v25, v163
    v_mul_f32 v26, v26, v163
    v_mul_f32 v27, v27, v163
    v_mul_f32 v28, v28, v163
    v_mul_f32 v29, v29, v163
    v_mul_f32 v30, v30, v163
    v_mul_f32 v31, v31, v163
    v_mul_f32 v32, v32, v163
    v_mul_f32 v33, v33, v163
    v_mul_f32 v34, v34, v163
    v_mul_f32 v35, v35, v163
    v_cvt_pk_bf16_f32 v84, v52, v53
    v_cvt_pk_bf16_f32 v85, v54, v55
    v_cvt_pk_bf16_f32 v86, v56, v57
    v_cvt_pk_bf16_f32 v87, v58, v59
    v_cvt_pk_bf16_f32 v88, v60, v61
    v_cvt_pk_bf16_f32 v89, v62, v63
    v_cvt_pk_bf16_f32 v90, v64, v65
    v_cvt_pk_bf16_f32 v91, v66, v67
    s_waitcnt lgkmcnt(0)
    v_mfma_f32_32x32x16_bf16 v[20:35], v[108:111], v[84:87], v[20:35]
    v_mfma_f32_32x32x16_bf16 v[20:35], v[112:115], v[88:91], v[20:35]
    s_nop 15
    s_add_u32 s47, s47, 512
    s_add_u32 s48, s48, 512
    s_add_u32 s42, s42, 1
    s_cmp_lt_u32 s42, 64
    s_cbranch_scc1 L2_slow_tile
    v_mov_b32 v168, v20
    v_mov_b32 v169, v21
    v_mov_b32 v170, v22
    v_mov_b32 v171, v23
    v_mov_b32 v172, v24
    v_mov_b32 v173, v25
    v_mov_b32 v174, v26
    v_mov_b32 v175, v27
    v_mov_b32 v176, v28
    v_mov_b32 v177, v29
    v_mov_b32 v178, v30
    v_mov_b32 v179, v31
    v_mov_b32 v180, v32
    v_mov_b32 v181, v33
    v_mov_b32 v182, v34
    v_mov_b32 v183, v35
    s_branch L2_adone
L_end:
    s_endpgm
.section .rodata,"a"
.p2align 6
.amdhsa_kernel concat_heads__softmax_full_mha__linear_kernel_hedgehog__prompt_kernel
  .amdhsa_next_free_vgpr 256
  .amdhsa_next_free_sgpr 102
  .amdhsa_accum_offset 256
  .amdhsa_group_segment_fixed_size 0
  .amdhsa_kernarg_size 80
  .amdhsa_user_sgpr_count 2
  .amdhsa_user_sgpr_kernarg_segment_ptr 1
  .amdhsa_system_sgpr_workgroup_id_x 1
.end_amdhsa_kernel
```
